```python
import torch

def _softmax(x, axis=-1):
    return torch.softmax(x, dim=axis)
def _gelu(x):
    return torch.nn.functional.gelu(x, approximate="tanh")
def _silu(x):
    return torch.nn.functional.silu(x)
def _sigmoid(x):
    return torch.sigmoid(x)
def _layernorm(x, axis=-1, eps=1e-5):
    m = x.mean(dim=axis, keepdim=True)
    v = x.var(dim=axis, keepdim=True, unbiased=False)
    return (x - m) / torch.sqrt(v + eps)
def _scatter_add(tgt, idx, src, axis=0):
    return tgt.clone().index_add_(axis, idx, src)
def _segment_sum(src, seg, n):
    out = torch.zeros((n,) + src.shape[1:], dtype=src.dtype)
    return out.index_add_(0, seg, src)
def _pad(x, pw):
    flat = tuple(v for pair in reversed(pw) for v in pair)
    return torch.nn.functional.pad(x, flat)

kernel_name = 'concat_heads__sliding_local_dilated__mha_block__prompt'

def setup_inputs():

    _w = (lambda a: (lambda t: t.to(torch.bfloat16) if t.is_floating_point() else t)(torch.as_tensor(a)))
    def _A_setup():
        B, S, D = 1, 2048, 512
        return {
            "x": _w((lambda *s: torch.randn(*s, dtype=torch.bfloat16) * 0.4)(B, S, D)),
            "wqkv": _w((lambda *s: torch.randn(*s, dtype=torch.bfloat16) * 0.4)(D, 3 * D)),
            "wo": _w((lambda *s: torch.randn(*s, dtype=torch.bfloat16) * 0.05)(D, D)),
        }
    _A_in = _A_setup()

    def _B_setup():
        B, S, D, H = 1, 2048, 512, 32
        return {
            "x": _w((lambda *s: torch.randn(*s, dtype=torch.bfloat16) * 0.2)(B, S, D)),
            "wqkv": _w((lambda *s: torch.randn(*s, dtype=torch.bfloat16) * 0.4)(D, 3 * D)),
            "wo": _w((lambda *s: torch.randn(*s, dtype=torch.bfloat16) * 0.1)(D, D)),
        }
    _B_in = _B_setup()

    return {
        "A_x": _A_in["x"],
        "A_wqkv": _A_in["wqkv"],
        "A_wo": _A_in["wo"],
        "B_x": _B_in["x"],
        "B_wqkv": _B_in["wqkv"],
        "B_wo": _B_in["wo"],
    }

def reference(A_x, A_wqkv, A_wo, B_x, B_wqkv, B_wo):
    def _A_ref(x, wqkv, wo):
        B, S, D = x.shape
        H = 32; Dh = D // H
        W, dil = 8, 2
        qkv = (lambda x, *d: x.permute(*d))((x @ wqkv).reshape(B, S, 3, H, Dh), 2, 0, 3, 1, 4)
        q, k, v = qkv[0], qkv[1], qkv[2]
        scale = Dh ** -0.5
        pos = torch.arange(S)
        off = torch.arange(W) * dil
        idx = pos[:, None] - off[None, :]
        mask = idx >= 0
        idx_c = torch.where(mask, idx, 0).reshape(-1)
        kg = k[:, :, idx_c, :].reshape(B, H, S, W, Dh)
        vg = v[:, :, idx_c, :].reshape(B, H, S, W, Dh)
        logits = torch.einsum("bhsd,bhswd->bhsw", q, kg) * scale
        logits = torch.where(mask[None, None, :, :], logits, -1e9)
        attn = _softmax(logits, axis=-1)
        o = torch.einsum("bhsw,bhswd->bhsd", attn, vg)
        return (lambda x, *d: x.permute(*d))(o, 0, 2, 1, 3).reshape(B, S, D) @ wo

    def _B_ref(x, wqkv, wo):
        B, S, D = x.shape
        H = 32
        Dh = D // H
        qkv = (lambda x, *d: x.permute(*d))((x @ wqkv).reshape(B, S, 3, H, Dh), 2, 0, 3, 1, 4)
        q, k, v = qkv[0], qkv[1], qkv[2]
        scores = torch.einsum("bhqd,bhkd->bhqk", q, k) * (Dh ** -0.5)
        p = _softmax(scores, axis=-1)
        o = torch.einsum("bhqk,bhkd->bhqd", p, v)
        return (lambda x, *d: x.permute(*d))(o, 0, 2, 1, 3).reshape(B, S, D) @ wo

    a = _A_ref(A_x, A_wqkv, A_wo)
    b = _B_ref(B_x, B_wqkv, B_wo)
    return torch.concatenate([a, b], axis=-1)
```

```asm
; @launch kernel=k1_qkv_kernel grid=(256,1,1) block=(512,1,1) lds=129024
; @launch kernel=k2_attn_kernel grid=(512,1,1) block=(512,1,1) lds=139264
.amdgcn_target "amdgcn-amd-amdhsa--gfx950"
.text
.globl k1_qkv_kernel
.p2align 8
.type k1_qkv_kernel,@function
k1_qkv_kernel:
    s_cmp_ge_u32 s2, 256
    s_cbranch_scc1 k1_end
    s_and_b32 s20, s2, 7
    s_lshr_b32 s21, s2, 3
    s_lshr_b32 s12, s20, 2
    s_mul_i32 s22, s12, 24
    s_add_u32 s22, s0, s22
    s_addc_u32 s23, s1, 0
    s_load_dwordx2 s[4:5], s[22:23], 0
    s_load_dwordx2 s[8:9], s[22:23], 8
    v_lshrrev_b32 v208, 6, v0
    v_and_b32 v206, 63, v0
    s_mov_b32 s6, 0x200000
    v_readfirstlane_b32 s15, v208
    s_mov_b32 s7, 0x00020000
    s_mov_b32 s10, 0x180000
    s_mov_b32 s11, 0x00020000
    s_and_b32 s24, s20, 1
    s_lshl_b32 s24, s24, 3
    s_and_b32 s38, s21, 7
    s_add_u32 s13, s24, s38
    s_lshr_b32 s24, s20, 1
    s_and_b32 s24, s24, 1
    s_lshl_b32 s24, s24, 2
    s_lshr_b32 s25, s21, 3
    s_add_u32 s14, s24, s25
    s_sub_u32 s40, 11, s12
    s_lshr_b32 s45, s13, 3
    s_lshl_b32 s45, s45, 10
    s_lshl_b32 s46, s13, 17
    s_lshl_b32 s47, s38, 18
    s_add_u32 s47, s47, s45
    s_cmp_eq_u32 s12, 0
    s_cselect_b32 s46, s47, s46
    v_lshrrev_b32 v10, 3, v206
    v_and_b32 v11, 7, v206
    s_cmp_lt_u32 s15, 4
    s_cbranch_scc1 k1_compute
    s_sub_u32 s16, s15, 4
    v_lshrrev_b32 v12, 4, v206
    v_xor_b32 v11, v11, v12
    v_lshlrev_b32 v11, 4, v11
    v_lshlrev_b32 v13, s40, v10
    v_add_u32 v1, v13, v11
    v_xor_b32 v2, 64, v1
    s_add_u32 s47, s40, 5
    s_lshl_b32 s47, s16, s47
    s_add_u32 s46, s46, s47
    s_add_u32 s47, s40, 3
    s_lshl_b32 s47, 1, s47
    s_lshl_b32 s50, s16, 12
    s_add_u32 s50, s50, 2048
    v_bfe_u32 v13, v206, 1, 2
    v_bfe_u32 v14, v206, 4, 1
    v_xor_b32 v13, v13, v14
    v_lshlrev_b32 v13, 5, v13
    v_and_b32 v14, 1, v206
    v_lshl_add_u32 v13, v14, 4, v13
    v_mul_u32_u24 v14, 3072, v10
    v_add_u32 v3, v13, v14
    v_xor_b32 v4, 64, v3
    s_mul_i32 s48, s16, 49152
    s_lshl_b32 s49, s14, 7
    s_add_u32 s48, s48, s49
    s_lshl_b32 s51, s16, 11
    s_add_u32 s51, s51, 18432
    s_lshl_b32 s42, s38, 7
    s_lshl_b32 s43, s16, 3
    s_add_u32 s43, s43, s42
    s_sub_u32 s43, s43, 16
    v_add_u32 v15, s43, v10
    v_max_i32 v15, 0, v15
    v_lshlrev_b32 v15, 11, v15
    s_lshl_b32 s44, s16, 6
    v_xor_b32 v14, s44, v11
    v_add_u32 v5, v15, v14
    s_lshl_b32 s52, s16, 10
    s_mov_b32 s53, s45
    s_lshl_b32 s55, s12, 2
    s_add_u32 s55, s55, s16
    s_mov_b32 s17, 0
    s_mov_b32 s18, 0
    s_waitcnt lgkmcnt(0)
k1_ldpro:
    s_add_u32 m0, s17, s50
    s_mov_b32 s54, s46
    buffer_load_dwordx4 v1, s[4:7], s54 offen lds
    s_add_u32 m0, m0, 1024
    s_add_u32 s54, s54, s47
    buffer_load_dwordx4 v2, s[4:7], s54 offen lds
    s_add_u32 m0, m0, 1024
    s_add_u32 s54, s54, s47
    buffer_load_dwordx4 v1, s[4:7], s54 offen lds
    s_add_u32 m0, m0, 1024
    s_add_u32 s54, s54, s47
    buffer_load_dwordx4 v2, s[4:7], s54 offen lds
    s_add_u32 m0, s17, s51
    s_mov_b32 s54, s48
    buffer_load_dwordx4 v3, s[8:11], s54 offen lds
    s_add_u32 m0, m0, 1024
    s_add_u32 s54, s54, 24576
    buffer_load_dwordx4 v4, s[8:11], s54 offen lds
    s_add_u32 m0, m0, 7168
    s_add_u32 s54, s54, 4294943744
    buffer_load_dwordx4 v3, s[8:11], s54 offen lds
    s_add_u32 m0, m0, 1024
    s_add_u32 s54, s54, 24576
    buffer_load_dwordx4 v4, s[8:11], s54 offen lds
    s_add_u32 m0, m0, 7168
    s_add_u32 s54, s54, 4294943744
    buffer_load_dwordx4 v3, s[8:11], s54 offen lds
    s_add_u32 m0, m0, 1024
    s_add_u32 s54, s54, 24576
    buffer_load_dwordx4 v4, s[8:11], s54 offen lds
    s_cmp_lt_u32 s55, 2
    s_cbranch_scc0 k1_nohalo0
    s_add_u32 m0, s17, s52
    s_nop 0
    buffer_load_dwordx4 v5, s[4:7], s53 offen lds
    s_add_u32 s53, s53, 128
k1_nohalo0:
    s_add_u32 s46, s46, 128
    s_add_u32 s48, s48, 196608
    s_add_u32 s17, s17, 43008
    s_cmp_eq_u32 s17, 129024
    s_cselect_b32 s17, 0, s17
    s_add_u32 s18, s18, 1
    s_cmp_lt_u32 s18, 2
    s_cbranch_scc1 k1_ldpro
    s_waitcnt vmcnt(10)
    s_barrier
    s_add_u32 m0, s17, s50
    s_mov_b32 s54, s46
    buffer_load_dwordx4 v1, s[4:7], s54 offen lds
    s_add_u32 m0, m0, 1024
    s_add_u32 s54, s54, s47
    buffer_load_dwordx4 v2, s[4:7], s54 offen lds
    s_add_u32 m0, m0, 1024
    s_add_u32 s54, s54, s47
    buffer_load_dwordx4 v1, s[4:7], s54 offen lds
    s_add_u32 m0, m0, 1024
    s_add_u32 s54, s54, s47
    buffer_load_dwordx4 v2, s[4:7], s54 offen lds
    s_add_u32 m0, s17, s51
    s_mov_b32 s54, s48
    buffer_load_dwordx4 v3, s[8:11], s54 offen lds
    s_add_u32 m0, m0, 1024
    s_add_u32 s54, s54, 24576
    buffer_load_dwordx4 v4, s[8:11], s54 offen lds
    s_add_u32 m0, m0, 7168
    s_add_u32 s54, s54, 4294943744
    buffer_load_dwordx4 v3, s[8:11], s54 offen lds
    s_add_u32 m0, m0, 1024
    s_add_u32 s54, s54, 24576
    buffer_load_dwordx4 v4, s[8:11], s54 offen lds
    s_add_u32 m0, m0, 7168
    s_add_u32 s54, s54, 4294943744
    buffer_load_dwordx4 v3, s[8:11], s54 offen lds
    s_add_u32 m0, m0, 1024
    s_add_u32 s54, s54, 24576
    buffer_load_dwordx4 v4, s[8:11], s54 offen lds
    s_cmp_lt_u32 s55, 2
    s_cbranch_scc0 k1_nohalo1
    s_add_u32 m0, s17, s52
    s_nop 0
    buffer_load_dwordx4 v5, s[4:7], s53 offen lds
    s_add_u32 s53, s53, 128
k1_nohalo1:
    s_add_u32 s46, s46, 128
    s_add_u32 s48, s48, 196608
    s_add_u32 s17, s17, 43008
    s_cmp_eq_u32 s17, 129024
    s_cselect_b32 s17, 0, s17
    s_mov_b32 s18, 0
k1_ld:
    s_waitcnt vmcnt(10)
    s_barrier
    s_add_u32 m0, s17, s50
    s_mov_b32 s54, s46
    buffer_load_dwordx4 v1, s[4:7], s54 offen lds
    s_add_u32 m0, m0, 1024
    s_add_u32 s54, s54, s47
    buffer_load_dwordx4 v2, s[4:7], s54 offen lds
    s_add_u32 m0, m0, 1024
    s_add_u32 s54, s54, s47
    buffer_load_dwordx4 v1, s[4:7], s54 offen lds
    s_add_u32 m0, m0, 1024
    s_add_u32 s54, s54, s47
    buffer_load_dwordx4 v2, s[4:7], s54 offen lds
    s_add_u32 m0, s17, s51
    s_mov_b32 s54, s48
    buffer_load_dwordx4 v3, s[8:11], s54 offen lds
    s_add_u32 m0, m0, 1024
    s_add_u32 s54, s54, 24576
    buffer_load_dwordx4 v4, s[8:11], s54 offen lds
    s_add_u32 m0, m0, 7168
    s_add_u32 s54, s54, 4294943744
    buffer_load_dwordx4 v3, s[8:11], s54 offen lds
    s_add_u32 m0, m0, 1024
    s_add_u32 s54, s54, 24576
    buffer_load_dwordx4 v4, s[8:11], s54 offen lds
    s_add_u32 m0, m0, 7168
    s_add_u32 s54, s54, 4294943744
    buffer_load_dwordx4 v3, s[8:11], s54 offen lds
    s_add_u32 m0, m0, 1024
    s_add_u32 s54, s54, 24576
    buffer_load_dwordx4 v4, s[8:11], s54 offen lds
    s_cmp_lt_u32 s55, 2
    s_cbranch_scc0 k1_nohalo2
    s_add_u32 m0, s17, s52
    s_nop 0
    buffer_load_dwordx4 v5, s[4:7], s53 offen lds
    s_add_u32 s53, s53, 128
k1_nohalo2:
    s_add_u32 s46, s46, 128
    s_add_u32 s48, s48, 196608
    s_add_u32 s17, s17, 43008
    s_cmp_eq_u32 s17, 129024
    s_cselect_b32 s17, 0, s17
    s_add_u32 s18, s18, 1
    s_cmp_lt_u32 s18, 5
    s_cbranch_scc1 k1_ld
    s_waitcnt vmcnt(10)
    s_barrier
    s_waitcnt vmcnt(0)
    s_barrier
    s_endpgm
k1_compute:
    s_load_dwordx2 s[56:57], s[0:1], 64
    s_lshl_b32 s27, s25, 2
    s_add_u32 s27, s27, s15
    s_lshl_b32 s27, s27, 3
    v_add_u32 v12, s27, v11
    v_lshlrev_b32 v234, s40, v12
    s_add_u32 s28, s46, 256
    s_lshl_b32 s27, s38, 2
    s_add_u32 s27, s27, s15
    s_lshl_b32 s27, s27, 1
    v_and_b32 v12, 1, v206
    v_add_u32 v12, s27, v12
    v_mul_u32_u24 v12, 3072, v12
    v_bfe_u32 v13, v206, 1, 2
    v_min_u32 v13, 2, v13
    v_lshl_add_u32 v235, v13, 10, v12
    s_lshl_b32 s29, s14, 7
    s_add_u32 s29, s29, 393216
    v_lshlrev_b32 v207, 4, v206
    v_and_b32 v208, 15, v206
    v_lshrrev_b32 v209, 4, v206
    v_lshrrev_b32 v210, 1, v208
    v_xor_b32 v210, v210, v209
    v_lshlrev_b32 v210, 4, v210
    v_lshl_add_u32 v203, v208, 7, v210
    v_xor_b32 v204, 64, v203
    v_bfe_u32 v210, v206, 2, 2
    v_lshl_add_u32 v211, v209, 3, v210
    v_lshlrev_b32 v211, 7, v211
    v_lshrrev_b32 v210, 1, v210
    v_and_b32 v212, 1, v209
    v_lshl_add_u32 v210, v212, 1, v210
    v_xor_b32 v210, s15, v210
    v_lshl_add_u32 v211, v210, 5, v211
    v_and_b32 v210, 3, v206
    v_lshl_add_u32 v205, v210, 3, v211
    v_add_u32 v205, 18432, v205
    v_mov_b32 v0, 0
    v_mov_b32 v1, 0
    v_mov_b32 v2, 0
    v_mov_b32 v3, 0
    v_mov_b32 v4, 0
    v_mov_b32 v5, 0
    v_mov_b32 v6, 0
    v_mov_b32 v7, 0
    v_mov_b32 v8, 0
    v_mov_b32 v9, 0
    v_mov_b32 v10, 0
    v_mov_b32 v11, 0
    v_mov_b32 v12, 0
    v_mov_b32 v13, 0
    v_mov_b32 v14, 0
    v_mov_b32 v15, 0
    v_mov_b32 v16, 0
    v_mov_b32 v17, 0
    v_mov_b32 v18, 0
    v_mov_b32 v19, 0
    v_mov_b32 v20, 0
    v_mov_b32 v21, 0
    v_mov_b32 v22, 0
    v_mov_b32 v23, 0
    v_mov_b32 v24, 0
    v_mov_b32 v25, 0
    v_mov_b32 v26, 0
    v_mov_b32 v27, 0
    v_mov_b32 v28, 0
    v_mov_b32 v29, 0
    v_mov_b32 v30, 0
    v_mov_b32 v31, 0
    v_mov_b32 v32, 0
    v_mov_b32 v33, 0
    v_mov_b32 v34, 0
    v_mov_b32 v35, 0
    v_mov_b32 v36, 0
    v_mov_b32 v37, 0
    v_mov_b32 v38, 0
    v_mov_b32 v39, 0
    v_mov_b32 v40, 0
    v_mov_b32 v41, 0
    v_mov_b32 v42, 0
    v_mov_b32 v43, 0
    v_mov_b32 v44, 0
    v_mov_b32 v45, 0
    v_mov_b32 v46, 0
    v_mov_b32 v47, 0
    v_mov_b32 v48, 0
    v_mov_b32 v49, 0
    v_mov_b32 v50, 0
    v_mov_b32 v51, 0
    v_mov_b32 v52, 0
    v_mov_b32 v53, 0
    v_mov_b32 v54, 0
    v_mov_b32 v55, 0
    v_mov_b32 v56, 0
    v_mov_b32 v57, 0
    v_mov_b32 v58, 0
    v_mov_b32 v59, 0
    v_mov_b32 v60, 0
    v_mov_b32 v61, 0
    v_mov_b32 v62, 0
    v_mov_b32 v63, 0
    v_mov_b32 v64, 0
    v_mov_b32 v65, 0
    v_mov_b32 v66, 0
    v_mov_b32 v67, 0
    v_mov_b32 v68, 0
    v_mov_b32 v69, 0
    v_mov_b32 v70, 0
    v_mov_b32 v71, 0
    v_mov_b32 v72, 0
    v_mov_b32 v73, 0
    v_mov_b32 v74, 0
    v_mov_b32 v75, 0
    v_mov_b32 v76, 0
    v_mov_b32 v77, 0
    v_mov_b32 v78, 0
    v_mov_b32 v79, 0
    v_mov_b32 v80, 0
    v_mov_b32 v81, 0
    v_mov_b32 v82, 0
    v_mov_b32 v83, 0
    v_mov_b32 v84, 0
    v_mov_b32 v85, 0
    v_mov_b32 v86, 0
    v_mov_b32 v87, 0
    v_mov_b32 v88, 0
    v_mov_b32 v89, 0
    v_mov_b32 v90, 0
    v_mov_b32 v91, 0
    v_mov_b32 v92, 0
    v_mov_b32 v93, 0
    v_mov_b32 v94, 0
    v_mov_b32 v95, 0
    v_mov_b32 v96, 0
    v_mov_b32 v97, 0
    v_mov_b32 v98, 0
    v_mov_b32 v99, 0
    v_mov_b32 v100, 0
    v_mov_b32 v101, 0
    v_mov_b32 v102, 0
    v_mov_b32 v103, 0
    v_mov_b32 v200, v203
    v_mov_b32 v201, v204
    v_mov_b32 v202, v205
    s_mov_b32 s17, 0
    s_mov_b32 s18, 0
    s_lshl_b32 s30, s14, 2
    s_add_u32 s30, s30, s15
    s_mov_b32 s58, 0xa01000
    s_mov_b32 s59, 0x00020000
    s_mov_b32 s36, 0x3eb8aa3b
    s_mov_b32 s37, 0x3eb8aa3b
    v_and_b32 v208, 15, v206
    v_lshrrev_b32 v209, 4, v206
    v_lshlrev_b32 v209, 2, v209
    v_sub_u32 v209, v209, v208
    v_mov_b32 v210, 0xff800000
    v_mov_b32 v211, 0
    s_cmp_eq_u32 s38, 0
    s_cselect_b32 s39, 0xff800000, 0
    v_add_u32 v212, 7, v209
    v_cmp_gt_u32 vcc, 8, v212
    s_nop 1
    v_cndmask_b32 v218, v210, v211, vcc
    v_add_u32 v212, 0, v209
    v_cmp_lt_i32 vcc, 8, v212
    s_nop 1
    v_cndmask_b32 v214, v210, v211, vcc
    v_add_u32 v212, 8, v209
    v_cmp_gt_u32 vcc, 8, v212
    s_nop 1
    v_cndmask_b32 v219, v210, v211, vcc
    v_add_u32 v212, 1, v209
    v_cmp_lt_i32 vcc, 8, v212
    s_nop 1
    v_cndmask_b32 v215, v210, v211, vcc
    v_add_u32 v212, 9, v209
    v_cmp_gt_u32 vcc, 8, v212
    s_nop 1
    v_cndmask_b32 v220, v210, v211, vcc
    v_add_u32 v212, 2, v209
    v_cmp_lt_i32 vcc, 8, v212
    s_nop 1
    v_cndmask_b32 v216, v210, v211, vcc
    v_add_u32 v212, 10, v209
    v_cmp_gt_u32 vcc, 8, v212
    s_nop 1
    v_cndmask_b32 v221, v210, v211, vcc
    v_add_u32 v212, 3, v209
    v_cmp_lt_i32 vcc, 8, v212
    s_nop 1
    v_cndmask_b32 v217, v210, v211, vcc
    v_add_f32 v222, s39, v214
    v_mov_b32 v226, 0x3f803f80
    v_add_f32 v223, s39, v215
    v_mov_b32 v227, 0x3f803f80
    v_add_f32 v224, s39, v216
    v_mov_b32 v228, 0x3f803f80
    v_add_f32 v225, s39, v217
    v_mov_b32 v229, 0x3f803f80
    v_mov_b32 v210, 0xffff
    v_add_u32 v212, 0, v209
    v_cmp_ge_i32 vcc, 0, v212
    s_nop 1
    v_cndmask_b32 v232, v211, v210, vcc
    v_mov_b32 v210, 0xffff0000
    v_add_u32 v212, 1, v209
    v_cmp_ge_i32 vcc, 0, v212
    s_nop 1
    v_cndmask_b32 v212, v211, v210, vcc
    v_or_b32 v232, v232, v212
    v_not_b32 v230, v232
    v_mov_b32 v210, 0xffff
    v_add_u32 v212, 2, v209
    v_cmp_ge_i32 vcc, 0, v212
    s_nop 1
    v_cndmask_b32 v233, v211, v210, vcc
    v_mov_b32 v210, 0xffff0000
    v_add_u32 v212, 3, v209
    v_cmp_ge_i32 vcc, 0, v212
    s_nop 1
    v_cndmask_b32 v212, v211, v210, vcc
    v_or_b32 v233, v233, v212
    v_not_b32 v231, v233
    s_waitcnt lgkmcnt(0)
    buffer_load_dword v213, v234, s[4:7], s28 offen
    buffer_load_dword v213, v235, s[8:11], s29 offen
    s_add_u32 s28, s28, 128
    s_add_u32 s29, s29, 196608
    buffer_load_dword v213, v234, s[4:7], s28 offen
    buffer_load_dword v213, v235, s[8:11], s29 offen
    s_add_u32 s28, s28, 128
    s_add_u32 s29, s29, 196608
    s_cmp_eq_u32 s12, 0
    s_cbranch_scc0 k1_compB
    s_barrier
    ds_read_b64_tr_b16 v[176:177], v202 offset:0
    ds_read_b64_tr_b16 v[178:179], v202 offset:512
    ds_read_b64_tr_b16 v[180:181], v202 offset:8192
    ds_read_b64_tr_b16 v[182:183], v202 offset:8704
    ds_read_b64_tr_b16 v[184:185], v202 offset:16384
    ds_read_b64_tr_b16 v[186:187], v202 offset:16896
    ds_read_b128 v[104:107], v200 offset:0
    ds_read_b128 v[108:111], v200 offset:2048
    ds_read_b128 v[112:115], v200 offset:4096
    ds_read_b128 v[116:119], v200 offset:6144
    ds_read_b128 v[120:123], v200 offset:8192
    ds_read_b128 v[124:127], v200 offset:10240
    ds_read_b128 v[128:131], v200 offset:12288
    ds_read_b128 v[132:135], v200 offset:14336
    ds_read_b128 v[136:139], v200 offset:16384
k1_loopA:
    s_cmp_lt_u32 s18, 4
    s_cbranch_scc0 k1_notouchA
    buffer_load_dword v213, v234, s[4:7], s28 offen
    buffer_load_dword v213, v235, s[8:11], s29 offen
    s_add_u32 s28, s28, 128
    s_add_u32 s29, s29, 196608
k1_notouchA:
    s_waitcnt lgkmcnt(0)
    v_mfma_f32_16x16x32_bf16 v[32:35], v[180:183], v[104:107], v[32:35]
    ds_read_b64_tr_b16 v[188:189], v202 offset:4096
    v_mfma_f32_16x16x32_bf16 v[68:71], v[104:107], v[184:187], v[68:71]
    ds_read_b64_tr_b16 v[190:191], v202 offset:4608
    v_mfma_f32_16x16x32_bf16 v[0:3], v[176:179], v[108:111], v[0:3]
    ds_read_b64_tr_b16 v[192:193], v202 offset:12288
    v_mfma_f32_16x16x32_bf16 v[36:39], v[180:183], v[108:111], v[36:39]
    ds_read_b64_tr_b16 v[194:195], v202 offset:12800
    v_mfma_f32_16x16x32_bf16 v[72:75], v[108:111], v[184:187], v[72:75]
    ds_read_b64_tr_b16 v[196:197], v202 offset:20480
    v_mfma_f32_16x16x32_bf16 v[4:7], v[176:179], v[112:115], v[4:7]
    ds_read_b64_tr_b16 v[198:199], v202 offset:20992
    v_mfma_f32_16x16x32_bf16 v[40:43], v[180:183], v[112:115], v[40:43]
    ds_read_b128 v[140:143], v201 offset:0
    v_mfma_f32_16x16x32_bf16 v[76:79], v[112:115], v[184:187], v[76:79]
    ds_read_b128 v[144:147], v201 offset:2048
    v_mfma_f32_16x16x32_bf16 v[8:11], v[176:179], v[116:119], v[8:11]
    ds_read_b128 v[148:151], v201 offset:4096
    v_mfma_f32_16x16x32_bf16 v[44:47], v[180:183], v[116:119], v[44:47]
    ds_read_b128 v[152:155], v201 offset:6144
    v_mfma_f32_16x16x32_bf16 v[80:83], v[116:119], v[184:187], v[80:83]
    ds_read_b128 v[156:159], v201 offset:8192
    v_mfma_f32_16x16x32_bf16 v[12:15], v[176:179], v[120:123], v[12:15]
    ds_read_b128 v[160:163], v201 offset:10240
    v_mfma_f32_16x16x32_bf16 v[48:51], v[180:183], v[120:123], v[48:51]
    ds_read_b128 v[164:167], v201 offset:12288
    v_mfma_f32_16x16x32_bf16 v[84:87], v[120:123], v[184:187], v[84:87]
    ds_read_b128 v[168:171], v201 offset:14336
    v_mfma_f32_16x16x32_bf16 v[16:19], v[176:179], v[124:127], v[16:19]
    ds_read_b128 v[172:175], v201 offset:16384
    v_mfma_f32_16x16x32_bf16 v[52:55], v[180:183], v[124:127], v[52:55]
    v_mfma_f32_16x16x32_bf16 v[88:91], v[124:127], v[184:187], v[88:91]
    v_mfma_f32_16x16x32_bf16 v[20:23], v[176:179], v[128:131], v[20:23]
    v_mfma_f32_16x16x32_bf16 v[56:59], v[180:183], v[128:131], v[56:59]
    v_mfma_f32_16x16x32_bf16 v[92:95], v[128:131], v[184:187], v[92:95]
    v_mfma_f32_16x16x32_bf16 v[24:27], v[176:179], v[132:135], v[24:27]
    v_mfma_f32_16x16x32_bf16 v[60:63], v[180:183], v[132:135], v[60:63]
    v_mfma_f32_16x16x32_bf16 v[96:99], v[132:135], v[184:187], v[96:99]
    v_mfma_f32_16x16x32_bf16 v[28:31], v[176:179], v[136:139], v[28:31]
    v_mfma_f32_16x16x32_bf16 v[64:67], v[180:183], v[136:139], v[64:67]
    v_mfma_f32_16x16x32_bf16 v[100:103], v[136:139], v[184:187], v[100:103]
    s_add_u32 s17, s17, 43008
    s_cmp_eq_u32 s17, 129024
    s_cselect_b32 s17, 0, s17
    s_add_u32 s18, s18, 1
    s_waitcnt lgkmcnt(0)
    s_barrier
    v_add_u32 v200, s17, v203
    v_add_u32 v202, s17, v205
    v_mfma_f32_16x16x32_bf16 v[32:35], v[192:195], v[140:143], v[32:35]
    ds_read_b64_tr_b16 v[176:177], v202 offset:0
    v_mfma_f32_16x16x32_bf16 v[68:71], v[140:143], v[196:199], v[68:71]
    ds_read_b64_tr_b16 v[178:179], v202 offset:512
    v_mfma_f32_16x16x32_bf16 v[0:3], v[188:191], v[144:147], v[0:3]
    ds_read_b64_tr_b16 v[180:181], v202 offset:8192
    v_mfma_f32_16x16x32_bf16 v[36:39], v[192:195], v[144:147], v[36:39]
    ds_read_b64_tr_b16 v[182:183], v202 offset:8704
    v_mfma_f32_16x16x32_bf16 v[72:75], v[144:147], v[196:199], v[72:75]
    ds_read_b64_tr_b16 v[184:185], v202 offset:16384
    v_mfma_f32_16x16x32_bf16 v[4:7], v[188:191], v[148:151], v[4:7]
    ds_read_b64_tr_b16 v[186:187], v202 offset:16896
    v_mfma_f32_16x16x32_bf16 v[40:43], v[192:195], v[148:151], v[40:43]
    ds_read_b128 v[104:107], v200 offset:0
    v_mfma_f32_16x16x32_bf16 v[76:79], v[148:151], v[196:199], v[76:79]
    ds_read_b128 v[108:111], v200 offset:2048
    v_mfma_f32_16x16x32_bf16 v[8:11], v[188:191], v[152:155], v[8:11]
    ds_read_b128 v[112:115], v200 offset:4096
    v_mfma_f32_16x16x32_bf16 v[44:47], v[192:195], v[152:155], v[44:47]
    ds_read_b128 v[116:119], v200 offset:6144
    v_mfma_f32_16x16x32_bf16 v[80:83], v[152:155], v[196:199], v[80:83]
    ds_read_b128 v[120:123], v200 offset:8192
    v_mfma_f32_16x16x32_bf16 v[12:15], v[188:191], v[156:159], v[12:15]
    ds_read_b128 v[124:127], v200 offset:10240
    v_mfma_f32_16x16x32_bf16 v[48:51], v[192:195], v[156:159], v[48:51]
    ds_read_b128 v[128:131], v200 offset:12288
    v_mfma_f32_16x16x32_bf16 v[84:87], v[156:159], v[196:199], v[84:87]
    ds_read_b128 v[132:135], v200 offset:14336
    v_mfma_f32_16x16x32_bf16 v[16:19], v[188:191], v[160:163], v[16:19]
    ds_read_b128 v[136:139], v200 offset:16384
    v_mfma_f32_16x16x32_bf16 v[52:55], v[192:195], v[160:163], v[52:55]
    v_mfma_f32_16x16x32_bf16 v[88:91], v[160:163], v[196:199], v[88:91]
    v_mfma_f32_16x16x32_bf16 v[20:23], v[188:191], v[164:167], v[20:23]
    v_mfma_f32_16x16x32_bf16 v[56:59], v[192:195], v[164:167], v[56:59]
    v_mfma_f32_16x16x32_bf16 v[92:95], v[164:167], v[196:199], v[92:95]
    v_mfma_f32_16x16x32_bf16 v[24:27], v[188:191], v[168:171], v[24:27]
    v_mfma_f32_16x16x32_bf16 v[60:63], v[192:195], v[168:171], v[60:63]
    v_mfma_f32_16x16x32_bf16 v[96:99], v[168:171], v[196:199], v[96:99]
    v_mfma_f32_16x16x32_bf16 v[28:31], v[188:191], v[172:175], v[28:31]
    v_mfma_f32_16x16x32_bf16 v[64:67], v[192:195], v[172:175], v[64:67]
    v_mfma_f32_16x16x32_bf16 v[100:103], v[172:175], v[196:199], v[100:103]
    v_add_u32 v201, s17, v204
    s_cmp_lt_u32 s18, 7
    s_cbranch_scc1 k1_loopA
    s_waitcnt lgkmcnt(0)
    v_mfma_f32_16x16x32_bf16 v[32:35], v[180:183], v[104:107], v[32:35]
    ds_read_b64_tr_b16 v[188:189], v202 offset:4096
    v_mfma_f32_16x16x32_bf16 v[68:71], v[104:107], v[184:187], v[68:71]
    ds_read_b64_tr_b16 v[190:191], v202 offset:4608
    v_mfma_f32_16x16x32_bf16 v[0:3], v[176:179], v[108:111], v[0:3]
    ds_read_b64_tr_b16 v[192:193], v202 offset:12288
    v_mfma_f32_16x16x32_bf16 v[36:39], v[180:183], v[108:111], v[36:39]
    ds_read_b64_tr_b16 v[194:195], v202 offset:12800
    v_mfma_f32_16x16x32_bf16 v[72:75], v[108:111], v[184:187], v[72:75]
    ds_read_b64_tr_b16 v[196:197], v202 offset:20480
    v_mfma_f32_16x16x32_bf16 v[4:7], v[176:179], v[112:115], v[4:7]
    ds_read_b64_tr_b16 v[198:199], v202 offset:20992
    v_mfma_f32_16x16x32_bf16 v[40:43], v[180:183], v[112:115], v[40:43]
    ds_read_b128 v[140:143], v201 offset:0
    v_mfma_f32_16x16x32_bf16 v[76:79], v[112:115], v[184:187], v[76:79]
    ds_read_b128 v[144:147], v201 offset:2048
    v_mfma_f32_16x16x32_bf16 v[8:11], v[176:179], v[116:119], v[8:11]
    ds_read_b128 v[148:151], v201 offset:4096
    v_mfma_f32_16x16x32_bf16 v[44:47], v[180:183], v[116:119], v[44:47]
    ds_read_b128 v[152:155], v201 offset:6144
    v_mfma_f32_16x16x32_bf16 v[80:83], v[116:119], v[184:187], v[80:83]
    ds_read_b128 v[156:159], v201 offset:8192
    v_mfma_f32_16x16x32_bf16 v[12:15], v[176:179], v[120:123], v[12:15]
    ds_read_b128 v[160:163], v201 offset:10240
    v_mfma_f32_16x16x32_bf16 v[48:51], v[180:183], v[120:123], v[48:51]
    ds_read_b128 v[164:167], v201 offset:12288
    v_mfma_f32_16x16x32_bf16 v[84:87], v[120:123], v[184:187], v[84:87]
    ds_read_b128 v[168:171], v201 offset:14336
    v_mfma_f32_16x16x32_bf16 v[16:19], v[176:179], v[124:127], v[16:19]
    ds_read_b128 v[172:175], v201 offset:16384
    v_mfma_f32_16x16x32_bf16 v[52:55], v[180:183], v[124:127], v[52:55]
    v_mfma_f32_16x16x32_bf16 v[88:91], v[124:127], v[184:187], v[88:91]
    v_mfma_f32_16x16x32_bf16 v[20:23], v[176:179], v[128:131], v[20:23]
    v_mfma_f32_16x16x32_bf16 v[56:59], v[180:183], v[128:131], v[56:59]
    v_mfma_f32_16x16x32_bf16 v[92:95], v[128:131], v[184:187], v[92:95]
    v_mfma_f32_16x16x32_bf16 v[24:27], v[176:179], v[132:135], v[24:27]
    v_mfma_f32_16x16x32_bf16 v[60:63], v[180:183], v[132:135], v[60:63]
    v_mfma_f32_16x16x32_bf16 v[96:99], v[132:135], v[184:187], v[96:99]
    v_mfma_f32_16x16x32_bf16 v[28:31], v[176:179], v[136:139], v[28:31]
    v_mfma_f32_16x16x32_bf16 v[64:67], v[180:183], v[136:139], v[64:67]
    v_mfma_f32_16x16x32_bf16 v[100:103], v[136:139], v[184:187], v[100:103]
    s_waitcnt vmcnt(0) lgkmcnt(0)
    v_mfma_f32_16x16x32_bf16 v[32:35], v[192:195], v[140:143], v[32:35]
    v_mfma_f32_16x16x32_bf16 v[68:71], v[140:143], v[196:199], v[68:71]
    v_mfma_f32_16x16x32_bf16 v[0:3], v[188:191], v[144:147], v[0:3]
    v_mfma_f32_16x16x32_bf16 v[36:39], v[192:195], v[144:147], v[36:39]
    v_mfma_f32_16x16x32_bf16 v[72:75], v[144:147], v[196:199], v[72:75]
    v_mfma_f32_16x16x32_bf16 v[4:7], v[188:191], v[148:151], v[4:7]
    s_nop 2
    v_cvt_pk_bf16_f32 v122, v32, v33
    v_cvt_pk_bf16_f32 v123, v34, v35
    v_mfma_f32_16x16x32_bf16 v[40:43], v[192:195], v[148:151], v[40:43]
    v_cvt_pk_bf16_f32 v104, v68, v69
    v_cvt_pk_bf16_f32 v105, v70, v71
    v_mfma_f32_16x16x32_bf16 v[76:79], v[148:151], v[196:199], v[76:79]
    v_mfma_f32_16x16x32_bf16 v[8:11], v[188:191], v[152:155], v[8:11]
    v_cvt_pk_bf16_f32 v124, v36, v37
    v_cvt_pk_bf16_f32 v125, v38, v39
    v_mfma_f32_16x16x32_bf16 v[44:47], v[192:195], v[152:155], v[44:47]
    v_cvt_pk_bf16_f32 v106, v72, v73
    v_cvt_pk_bf16_f32 v107, v74, v75
    v_mfma_f32_16x16x32_bf16 v[80:83], v[152:155], v[196:199], v[80:83]
    v_cvt_pk_bf16_f32 v176, v0, v1
    v_cvt_pk_bf16_f32 v177, v2, v3
    v_mfma_f32_16x16x32_bf16 v[12:15], v[188:191], v[156:159], v[12:15]
    v_cvt_pk_bf16_f32 v126, v40, v41
    v_cvt_pk_bf16_f32 v127, v42, v43
    v_mfma_f32_16x16x32_bf16 v[48:51], v[192:195], v[156:159], v[48:51]
    v_cvt_pk_bf16_f32 v108, v76, v77
    v_cvt_pk_bf16_f32 v109, v78, v79
    v_mfma_f32_16x16x32_bf16 v[84:87], v[156:159], v[196:199], v[84:87]
    v_cvt_pk_bf16_f32 v178, v4, v5
    v_cvt_pk_bf16_f32 v179, v6, v7
    v_mfma_f32_16x16x32_bf16 v[16:19], v[188:191], v[160:163], v[16:19]
    v_cvt_pk_bf16_f32 v128, v44, v45
    v_cvt_pk_bf16_f32 v129, v46, v47
    v_mfma_f32_16x16x32_bf16 v[52:55], v[192:195], v[160:163], v[52:55]
    v_cvt_pk_bf16_f32 v110, v80, v81
    v_cvt_pk_bf16_f32 v111, v82, v83
    v_mfma_f32_16x16x32_bf16 v[88:91], v[160:163], v[196:199], v[88:91]
    v_cvt_pk_bf16_f32 v180, v8, v9
    v_cvt_pk_bf16_f32 v181, v10, v11
    v_mfma_f32_16x16x32_bf16 v[20:23], v[188:191], v[164:167], v[20:23]
    v_cvt_pk_bf16_f32 v130, v48, v49
    v_cvt_pk_bf16_f32 v131, v50, v51
    v_mfma_f32_16x16x32_bf16 v[56:59], v[192:195], v[164:167], v[56:59]
    v_cvt_pk_bf16_f32 v112, v84, v85
    v_cvt_pk_bf16_f32 v113, v86, v87
    v_mfma_f32_16x16x32_bf16 v[92:95], v[164:167], v[196:199], v[92:95]
    v_cvt_pk_bf16_f32 v182, v12, v13
    v_cvt_pk_bf16_f32 v183, v14, v15
    v_mfma_f32_16x16x32_bf16 v[24:27], v[188:191], v[168:171], v[24:27]
    v_cvt_pk_bf16_f32 v132, v52, v53
    v_cvt_pk_bf16_f32 v133, v54, v55
    v_mfma_f32_16x16x32_bf16 v[60:63], v[192:195], v[168:171], v[60:63]
    v_cvt_pk_bf16_f32 v114, v88, v89
    v_cvt_pk_bf16_f32 v115, v90, v91
    v_mfma_f32_16x16x32_bf16 v[96:99], v[168:171], v[196:199], v[96:99]
    v_cvt_pk_bf16_f32 v184, v16, v17
    v_cvt_pk_bf16_f32 v185, v18, v19
    v_mfma_f32_16x16x32_bf16 v[28:31], v[188:191], v[172:175], v[28:31]
    v_cvt_pk_bf16_f32 v134, v56, v57
    v_cvt_pk_bf16_f32 v135, v58, v59
    v_mfma_f32_16x16x32_bf16 v[64:67], v[192:195], v[172:175], v[64:67]
    v_cvt_pk_bf16_f32 v116, v92, v93
    v_cvt_pk_bf16_f32 v117, v94, v95
    v_mfma_f32_16x16x32_bf16 v[100:103], v[172:175], v[196:199], v[100:103]
    v_cvt_pk_bf16_f32 v186, v20, v21
    v_cvt_pk_bf16_f32 v187, v22, v23
    v_cvt_pk_bf16_f32 v136, v60, v61
    v_cvt_pk_bf16_f32 v137, v62, v63
    v_cvt_pk_bf16_f32 v118, v96, v97
    v_cvt_pk_bf16_f32 v119, v98, v99
    v_cvt_pk_bf16_f32 v140, v24, v25
    v_cvt_pk_bf16_f32 v141, v26, v27
    v_cvt_pk_bf16_f32 v138, v64, v65
    v_cvt_pk_bf16_f32 v139, v66, v67
    v_cvt_pk_bf16_f32 v120, v100, v101
    v_cvt_pk_bf16_f32 v121, v102, v103
    v_cvt_pk_bf16_f32 v142, v28, v29
    v_cvt_pk_bf16_f32 v143, v30, v31
    v_mfma_f32_16x16x16_bf16 v[0:3], v[122:123], v[176:177], v[222:225]
    v_mfma_f32_16x16x16_bf16 v[4:7], v[124:125], v[176:177], v[218:221]
    v_mfma_f32_16x16x16_bf16 v[8:11], v[124:125], v[178:179], v[214:217]
    v_mfma_f32_16x16x16_bf16 v[12:15], v[126:127], v[178:179], v[218:221]
    v_mfma_f32_16x16x16_bf16 v[16:19], v[126:127], v[180:181], v[214:217]
    v_mfma_f32_16x16x16_bf16 v[20:23], v[128:129], v[180:181], v[218:221]
    v_mfma_f32_16x16x16_bf16 v[24:27], v[128:129], v[182:183], v[214:217]
    v_mfma_f32_16x16x16_bf16 v[28:31], v[130:131], v[182:183], v[218:221]
    v_mfma_f32_16x16x16_bf16 v[32:35], v[130:131], v[184:185], v[214:217]
    v_mfma_f32_16x16x16_bf16 v[36:39], v[132:133], v[184:185], v[218:221]
    v_mfma_f32_16x16x16_bf16 v[40:43], v[132:133], v[186:187], v[214:217]
    v_mfma_f32_16x16x16_bf16 v[44:47], v[134:135], v[186:187], v[218:221]
    v_mfma_f32_16x16x16_bf16 v[48:51], v[134:135], v[140:141], v[214:217]
    v_mfma_f32_16x16x16_bf16 v[52:55], v[136:137], v[140:141], v[218:221]
    v_mfma_f32_16x16x16_bf16 v[56:59], v[136:137], v[142:143], v[214:217]
    v_mfma_f32_16x16x16_bf16 v[60:63], v[138:139], v[142:143], v[218:221]
    v_max_f32 v0, v0, v4
    v_max_f32 v1, v1, v5
    v_max_f32 v2, v2, v6
    v_max_f32 v3, v3, v7
    v_max_f32 v8, v8, v12
    v_max_f32 v9, v9, v13
    v_max_f32 v10, v10, v14
    v_max_f32 v11, v11, v15
    v_max_f32 v16, v16, v20
    v_max_f32 v17, v17, v21
    v_max_f32 v18, v18, v22
    v_max_f32 v19, v19, v23
    v_max_f32 v24, v24, v28
    v_max_f32 v25, v25, v29
    v_max_f32 v26, v26, v30
    v_max_f32 v27, v27, v31
    v_max_f32 v32, v32, v36
    v_max_f32 v33, v33, v37
    v_max_f32 v34, v34, v38
    v_max_f32 v35, v35, v39
    v_max_f32 v40, v40, v44
    v_max_f32 v41, v41, v45
    v_max_f32 v42, v42, v46
    v_max_f32 v43, v43, v47
    v_max_f32 v48, v48, v52
    v_max_f32 v49, v49, v53
    v_max_f32 v50, v50, v54
    v_max_f32 v51, v51, v55
    v_max_f32 v56, v56, v60
    v_max_f32 v57, v57, v61
    v_max_f32 v58, v58, v62
    v_max_f32 v59, v59, v63
    v_max3_f32 v64, v0, v1, v2
    v_max3_f32 v65, v8, v9, v10
    v_max3_f32 v66, v16, v17, v18
    v_max3_f32 v67, v24, v25, v26
    v_max3_f32 v68, v32, v33, v34
    v_max3_f32 v69, v40, v41, v42
    v_max3_f32 v70, v48, v49, v50
    v_max3_f32 v71, v56, v57, v58
    v_max_f32 v64, v64, v3
    v_max_f32 v65, v65, v11
    v_max_f32 v66, v66, v19
    v_max_f32 v67, v67, v27
    v_max_f32 v68, v68, v35
    v_max_f32 v69, v69, v43
    v_max_f32 v70, v70, v51
    v_max_f32 v71, v71, v59
    v_permlane32_swap_b32 v64, v65
    v_permlane32_swap_b32 v66, v67
    v_permlane32_swap_b32 v68, v69
    v_permlane32_swap_b32 v70, v71
    v_max_f32 v64, v64, v65
    v_max_f32 v66, v66, v67
    v_max_f32 v68, v68, v69
    v_max_f32 v70, v70, v71
    v_permlane16_swap_b32 v64, v66
    s_nop 0
    v_permlane16_swap_b32 v68, v70
    v_max_f32 v64, v64, v66
    v_max_f32 v68, v68, v70
    s_mov_b32 s39, 0xbeb8aa3b
    v_mul_f32 v64, s39, v64
    v_mul_f32 v68, s39, v68
    v_mov_b32 v66, v64
    v_mov_b32 v70, v68
    s_nop 0
    v_permlane16_swap_b32 v64, v66
    v_permlane16_swap_b32 v68, v70
    v_mov_b32 v65, v64
    v_mov_b32 v67, v66
    v_mov_b32 v69, v68
    v_mov_b32 v71, v70
    v_permlane32_swap_b32 v64, v65
    v_permlane32_swap_b32 v66, v67
    v_permlane32_swap_b32 v68, v69
    v_permlane32_swap_b32 v70, v71
    v_pk_fma_f32 v[0:1], v[0:1], s[36:37], v[64:65] op_sel:[0,0,0] op_sel_hi:[1,1,0]
    v_pk_fma_f32 v[2:3], v[2:3], s[36:37], v[64:65] op_sel:[0,0,0] op_sel_hi:[1,1,0]
    v_pk_fma_f32 v[8:9], v[8:9], s[36:37], v[64:65] op_sel:[0,0,1] op_sel_hi:[1,1,1]
    v_pk_fma_f32 v[10:11], v[10:11], s[36:37], v[64:65] op_sel:[0,0,1] op_sel_hi:[1,1,1]
    v_pk_fma_f32 v[16:17], v[16:17], s[36:37], v[66:67] op_sel:[0,0,0] op_sel_hi:[1,1,0]
    v_pk_fma_f32 v[18:19], v[18:19], s[36:37], v[66:67] op_sel:[0,0,0] op_sel_hi:[1,1,0]
    v_pk_fma_f32 v[24:25], v[24:25], s[36:37], v[66:67] op_sel:[0,0,1] op_sel_hi:[1,1,1]
    v_pk_fma_f32 v[26:27], v[26:27], s[36:37], v[66:67] op_sel:[0,0,1] op_sel_hi:[1,1,1]
    v_pk_fma_f32 v[32:33], v[32:33], s[36:37], v[68:69] op_sel:[0,0,0] op_sel_hi:[1,1,0]
    v_pk_fma_f32 v[34:35], v[34:35], s[36:37], v[68:69] op_sel:[0,0,0] op_sel_hi:[1,1,0]
    v_pk_fma_f32 v[40:41], v[40:41], s[36:37], v[68:69] op_sel:[0,0,1] op_sel_hi:[1,1,1]
    v_pk_fma_f32 v[42:43], v[42:43], s[36:37], v[68:69] op_sel:[0,0,1] op_sel_hi:[1,1,1]
    v_pk_fma_f32 v[48:49], v[48:49], s[36:37], v[70:71] op_sel:[0,0,0] op_sel_hi:[1,1,0]
    v_pk_fma_f32 v[50:51], v[50:51], s[36:37], v[70:71] op_sel:[0,0,0] op_sel_hi:[1,1,0]
    v_pk_fma_f32 v[56:57], v[56:57], s[36:37], v[70:71] op_sel:[0,0,1] op_sel_hi:[1,1,1]
    v_pk_fma_f32 v[58:59], v[58:59], s[36:37], v[70:71] op_sel:[0,0,1] op_sel_hi:[1,1,1]
    v_exp_f32 v0, v0
    v_exp_f32 v1, v1
    v_exp_f32 v2, v2
    v_exp_f32 v3, v3
    v_exp_f32 v8, v8
    v_exp_f32 v9, v9
    v_exp_f32 v10, v10
    v_exp_f32 v11, v11
    v_cvt_pk_bf16_f32 v4, v0, v1
    v_cvt_pk_bf16_f32 v5, v2, v3
    v_exp_f32 v16, v16
    v_exp_f32 v17, v17
    v_exp_f32 v18, v18
    v_exp_f32 v19, v19
    v_cvt_pk_bf16_f32 v12, v8, v9
    v_cvt_pk_bf16_f32 v13, v10, v11
    v_exp_f32 v24, v24
    v_exp_f32 v25, v25
    v_exp_f32 v26, v26
    v_exp_f32 v27, v27
    v_cvt_pk_bf16_f32 v20, v16, v17
    v_cvt_pk_bf16_f32 v21, v18, v19
    v_exp_f32 v32, v32
    v_exp_f32 v33, v33
    v_exp_f32 v34, v34
    v_exp_f32 v35, v35
    v_cvt_pk_bf16_f32 v28, v24, v25
    v_cvt_pk_bf16_f32 v29, v26, v27
    v_exp_f32 v40, v40
    v_exp_f32 v41, v41
    v_exp_f32 v42, v42
    v_exp_f32 v43, v43
    v_cvt_pk_bf16_f32 v36, v32, v33
    v_cvt_pk_bf16_f32 v37, v34, v35
    v_exp_f32 v48, v48
    v_exp_f32 v49, v49
    v_exp_f32 v50, v50
    v_exp_f32 v51, v51
    v_cvt_pk_bf16_f32 v44, v40, v41
    v_cvt_pk_bf16_f32 v45, v42, v43
    v_exp_f32 v56, v56
    v_exp_f32 v57, v57
    v_exp_f32 v58, v58
    v_exp_f32 v59, v59
    v_cvt_pk_bf16_f32 v52, v48, v49
    v_cvt_pk_bf16_f32 v53, v50, v51
    v_cvt_pk_bf16_f32 v60, v56, v57
    v_cvt_pk_bf16_f32 v61, v58, v59
    v_and_b32 v72, v4, v230
    v_and_b32 v74, v4, v232
    v_and_b32 v73, v5, v231
    v_and_b32 v75, v5, v233
    v_and_b32 v76, v12, v230
    v_and_b32 v78, v12, v232
    v_and_b32 v77, v13, v231
    v_and_b32 v79, v13, v233
    v_and_b32 v80, v20, v230
    v_and_b32 v82, v20, v232
    v_and_b32 v81, v21, v231
    v_and_b32 v83, v21, v233
    v_and_b32 v84, v28, v230
    v_and_b32 v86, v28, v232
    v_and_b32 v85, v29, v231
    v_and_b32 v87, v29, v233
    v_and_b32 v88, v36, v230
    v_and_b32 v90, v36, v232
    v_and_b32 v89, v37, v231
    v_and_b32 v91, v37, v233
    v_and_b32 v92, v44, v230
    v_and_b32 v94, v44, v232
    v_and_b32 v93, v45, v231
    v_and_b32 v95, v45, v233
    v_and_b32 v96, v52, v230
    v_and_b32 v98, v52, v232
    v_and_b32 v97, v53, v231
    v_and_b32 v99, v53, v233
    v_and_b32 v100, v60, v230
    v_and_b32 v102, v60, v232
    v_and_b32 v101, v61, v231
    v_and_b32 v103, v61, v233
    v_mfma_f32_16x16x32_bf16 v[4:7], v[226:229], v[72:75], 0
    v_mfma_f32_16x16x32_bf16 v[0:3], v[104:107], v[72:75], 0
    v_mfma_f32_16x16x32_bf16 v[12:15], v[226:229], v[76:79], 0
    v_mfma_f32_16x16x32_bf16 v[8:11], v[106:109], v[76:79], 0
    v_mfma_f32_16x16x32_bf16 v[20:23], v[226:229], v[80:83], 0
    v_mfma_f32_16x16x32_bf16 v[16:19], v[108:111], v[80:83], 0
    v_mfma_f32_16x16x32_bf16 v[28:31], v[226:229], v[84:87], 0
    v_mfma_f32_16x16x32_bf16 v[24:27], v[110:113], v[84:87], 0
    v_mfma_f32_16x16x32_bf16 v[36:39], v[226:229], v[88:91], 0
    v_mfma_f32_16x16x32_bf16 v[32:35], v[112:115], v[88:91], 0
    v_mfma_f32_16x16x32_bf16 v[44:47], v[226:229], v[92:95], 0
    v_mfma_f32_16x16x32_bf16 v[40:43], v[114:117], v[92:95], 0
    v_mfma_f32_16x16x32_bf16 v[52:55], v[226:229], v[96:99], 0
    v_mfma_f32_16x16x32_bf16 v[48:51], v[116:119], v[96:99], 0
    v_mfma_f32_16x16x32_bf16 v[60:63], v[226:229], v[100:103], 0
    v_mfma_f32_16x16x32_bf16 v[56:59], v[118:121], v[100:103], 0
    s_lshl_b32 s31, s13, 17
    s_lshl_b32 s32, s30, 10
    s_add_u32 s32, s32, s31
    s_add_u32 s32, s32, 0x600000
    v_rcp_f32 v64, v4
    v_rcp_f32 v65, v12
    v_rcp_f32 v66, v20
    v_rcp_f32 v67, v28
    v_rcp_f32 v68, v36
    v_rcp_f32 v69, v44
    v_rcp_f32 v70, v52
    v_rcp_f32 v71, v60
    v_pk_mul_f32 v[0:1], v[0:1], v[64:65] op_sel:[0,0] op_sel_hi:[1,0]
    v_pk_mul_f32 v[2:3], v[2:3], v[64:65] op_sel:[0,0] op_sel_hi:[1,0]
    v_pk_mul_f32 v[8:9], v[8:9], v[64:65] op_sel:[0,1] op_sel_hi:[1,1]
    v_pk_mul_f32 v[10:11], v[10:11], v[64:65] op_sel:[0,1] op_sel_hi:[1,1]
    v_cvt_pk_bf16_f32 v104, v0, v1
    v_cvt_pk_bf16_f32 v105, v2, v3
    v_cvt_pk_bf16_f32 v106, v8, v9
    v_cvt_pk_bf16_f32 v107, v10, v11
    v_pk_mul_f32 v[16:17], v[16:17], v[66:67] op_sel:[0,0] op_sel_hi:[1,0]
    v_pk_mul_f32 v[18:19], v[18:19], v[66:67] op_sel:[0,0] op_sel_hi:[1,0]
    v_pk_mul_f32 v[24:25], v[24:25], v[66:67] op_sel:[0,1] op_sel_hi:[1,1]
    v_pk_mul_f32 v[26:27], v[26:27], v[66:67] op_sel:[0,1] op_sel_hi:[1,1]
    v_cvt_pk_bf16_f32 v108, v16, v17
    v_cvt_pk_bf16_f32 v109, v18, v19
    v_cvt_pk_bf16_f32 v110, v24, v25
    v_cvt_pk_bf16_f32 v111, v26, v27
    v_permlane16_swap_b32 v104, v106
    v_permlane16_swap_b32 v105, v107
    buffer_store_dwordx4 v[104:107], v207, s[56:59], s32 offen sc1
    s_add_u32 s32, s32, 32768
    v_pk_mul_f32 v[32:33], v[32:33], v[68:69] op_sel:[0,0] op_sel_hi:[1,0]
    v_pk_mul_f32 v[34:35], v[34:35], v[68:69] op_sel:[0,0] op_sel_hi:[1,0]
    v_pk_mul_f32 v[40:41], v[40:41], v[68:69] op_sel:[0,1] op_sel_hi:[1,1]
    v_pk_mul_f32 v[42:43], v[42:43], v[68:69] op_sel:[0,1] op_sel_hi:[1,1]
    v_cvt_pk_bf16_f32 v112, v32, v33
    v_cvt_pk_bf16_f32 v113, v34, v35
    v_cvt_pk_bf16_f32 v114, v40, v41
    v_cvt_pk_bf16_f32 v115, v42, v43
    v_permlane16_swap_b32 v108, v110
    v_permlane16_swap_b32 v109, v111
    buffer_store_dwordx4 v[108:111], v207, s[56:59], s32 offen sc1
    s_add_u32 s32, s32, 32768
    v_pk_mul_f32 v[48:49], v[48:49], v[70:71] op_sel:[0,0] op_sel_hi:[1,0]
    v_pk_mul_f32 v[50:51], v[50:51], v[70:71] op_sel:[0,0] op_sel_hi:[1,0]
    v_pk_mul_f32 v[56:57], v[56:57], v[70:71] op_sel:[0,1] op_sel_hi:[1,1]
    v_pk_mul_f32 v[58:59], v[58:59], v[70:71] op_sel:[0,1] op_sel_hi:[1,1]
    v_cvt_pk_bf16_f32 v116, v48, v49
    v_cvt_pk_bf16_f32 v117, v50, v51
    v_cvt_pk_bf16_f32 v118, v56, v57
    v_cvt_pk_bf16_f32 v119, v58, v59
    v_permlane16_swap_b32 v112, v114
    v_permlane16_swap_b32 v113, v115
    buffer_store_dwordx4 v[112:115], v207, s[56:59], s32 offen sc1
    s_add_u32 s32, s32, 32768
    v_permlane16_swap_b32 v116, v118
    v_permlane16_swap_b32 v117, v119
    buffer_store_dwordx4 v[116:119], v207, s[56:59], s32 offen sc1
    s_endpgm
k1_compB:
    s_lshl_b32 s31, s13, 2
    s_lshl_b32 s32, s30, 16
    s_lshl_b32 s33, s31, 10
    s_add_u32 s32, s32, s33
    s_add_u32 s32, s32, 0x400000
    s_lshl_b32 s34, s30, 17
    s_lshl_b32 s33, s31, 11
    s_add_u32 s34, s34, s33
    s_barrier
    ds_read_b64_tr_b16 v[176:177], v202 offset:0
    ds_read_b64_tr_b16 v[178:179], v202 offset:512
    ds_read_b64_tr_b16 v[180:181], v202 offset:8192
    ds_read_b64_tr_b16 v[182:183], v202 offset:8704
    ds_read_b64_tr_b16 v[184:185], v202 offset:16384
    ds_read_b64_tr_b16 v[186:187], v202 offset:16896
    ds_read_b128 v[108:111], v200 offset:2048
    ds_read_b128 v[112:115], v200 offset:4096
    ds_read_b128 v[116:119], v200 offset:6144
    ds_read_b128 v[120:123], v200 offset:8192
    ds_read_b128 v[124:127], v200 offset:10240
    ds_read_b128 v[128:131], v200 offset:12288
    ds_read_b128 v[132:135], v200 offset:14336
    ds_read_b128 v[136:139], v200 offset:16384
k1_loopB:
    s_cmp_lt_u32 s18, 4
    s_cbranch_scc0 k1_notouchB
    buffer_load_dword v213, v234, s[4:7], s28 offen
    buffer_load_dword v213, v235, s[8:11], s29 offen
    s_add_u32 s28, s28, 128
    s_add_u32 s29, s29, 196608
k1_notouchB:
    s_waitcnt lgkmcnt(0)
    v_mfma_f32_16x16x32_bf16 v[0:3], v[176:179], v[108:111], v[0:3]
    ds_read_b64_tr_b16 v[188:189], v202 offset:4096
    v_mfma_f32_16x16x32_bf16 v[36:39], v[180:183], v[108:111], v[36:39]
    ds_read_b64_tr_b16 v[190:191], v202 offset:4608
    v_mfma_f32_16x16x32_bf16 v[72:75], v[108:111], v[184:187], v[72:75]
    ds_read_b64_tr_b16 v[192:193], v202 offset:12288
    v_mfma_f32_16x16x32_bf16 v[4:7], v[176:179], v[112:115], v[4:7]
    ds_read_b64_tr_b16 v[194:195], v202 offset:12800
    v_mfma_f32_16x16x32_bf16 v[40:43], v[180:183], v[112:115], v[40:43]
    ds_read_b64_tr_b16 v[196:197], v202 offset:20480
    v_mfma_f32_16x16x32_bf16 v[76:79], v[112:115], v[184:187], v[76:79]
    ds_read_b64_tr_b16 v[198:199], v202 offset:20992
    v_mfma_f32_16x16x32_bf16 v[8:11], v[176:179], v[116:119], v[8:11]
    ds_read_b128 v[144:147], v201 offset:2048
    v_mfma_f32_16x16x32_bf16 v[44:47], v[180:183], v[116:119], v[44:47]
    ds_read_b128 v[148:151], v201 offset:4096
    v_mfma_f32_16x16x32_bf16 v[80:83], v[116:119], v[184:187], v[80:83]
    ds_read_b128 v[152:155], v201 offset:6144
    v_mfma_f32_16x16x32_bf16 v[12:15], v[176:179], v[120:123], v[12:15]
    ds_read_b128 v[156:159], v201 offset:8192
    v_mfma_f32_16x16x32_bf16 v[48:51], v[180:183], v[120:123], v[48:51]
    ds_read_b128 v[160:163], v201 offset:10240
    v_mfma_f32_16x16x32_bf16 v[84:87], v[120:123], v[184:187], v[84:87]
    ds_read_b128 v[164:167], v201 offset:12288
    v_mfma_f32_16x16x32_bf16 v[16:19], v[176:179], v[124:127], v[16:19]
    ds_read_b128 v[168:171], v201 offset:14336
    v_mfma_f32_16x16x32_bf16 v[52:55], v[180:183], v[124:127], v[52:55]
    ds_read_b128 v[172:175], v201 offset:16384
    v_mfma_f32_16x16x32_bf16 v[88:91], v[124:127], v[184:187], v[88:91]
    v_mfma_f32_16x16x32_bf16 v[20:23], v[176:179], v[128:131], v[20:23]
    v_mfma_f32_16x16x32_bf16 v[56:59], v[180:183], v[128:131], v[56:59]
    v_mfma_f32_16x16x32_bf16 v[92:95], v[128:131], v[184:187], v[92:95]
    v_mfma_f32_16x16x32_bf16 v[24:27], v[176:179], v[132:135], v[24:27]
    v_mfma_f32_16x16x32_bf16 v[60:63], v[180:183], v[132:135], v[60:63]
    v_mfma_f32_16x16x32_bf16 v[96:99], v[132:135], v[184:187], v[96:99]
    v_mfma_f32_16x16x32_bf16 v[28:31], v[176:179], v[136:139], v[28:31]
    v_mfma_f32_16x16x32_bf16 v[64:67], v[180:183], v[136:139], v[64:67]
    v_mfma_f32_16x16x32_bf16 v[100:103], v[136:139], v[184:187], v[100:103]
    s_add_u32 s17, s17, 43008
    s_cmp_eq_u32 s17, 129024
    s_cselect_b32 s17, 0, s17
    s_add_u32 s18, s18, 1
    s_waitcnt lgkmcnt(0)
    s_barrier
    v_add_u32 v200, s17, v203
    v_add_u32 v202, s17, v205
    v_mfma_f32_16x16x32_bf16 v[0:3], v[188:191], v[144:147], v[0:3]
    ds_read_b64_tr_b16 v[176:177], v202 offset:0
    v_mfma_f32_16x16x32_bf16 v[36:39], v[192:195], v[144:147], v[36:39]
    ds_read_b64_tr_b16 v[178:179], v202 offset:512
    v_mfma_f32_16x16x32_bf16 v[72:75], v[144:147], v[196:199], v[72:75]
    ds_read_b64_tr_b16 v[180:181], v202 offset:8192
    v_mfma_f32_16x16x32_bf16 v[4:7], v[188:191], v[148:151], v[4:7]
    ds_read_b64_tr_b16 v[182:183], v202 offset:8704
    v_mfma_f32_16x16x32_bf16 v[40:43], v[192:195], v[148:151], v[40:43]
    ds_read_b64_tr_b16 v[184:185], v202 offset:16384
    v_mfma_f32_16x16x32_bf16 v[76:79], v[148:151], v[196:199], v[76:79]
    ds_read_b64_tr_b16 v[186:187], v202 offset:16896
    v_mfma_f32_16x16x32_bf16 v[8:11], v[188:191], v[152:155], v[8:11]
    ds_read_b128 v[108:111], v200 offset:2048
    v_mfma_f32_16x16x32_bf16 v[44:47], v[192:195], v[152:155], v[44:47]
    ds_read_b128 v[112:115], v200 offset:4096
    v_mfma_f32_16x16x32_bf16 v[80:83], v[152:155], v[196:199], v[80:83]
    ds_read_b128 v[116:119], v200 offset:6144
    v_mfma_f32_16x16x32_bf16 v[12:15], v[188:191], v[156:159], v[12:15]
    ds_read_b128 v[120:123], v200 offset:8192
    v_mfma_f32_16x16x32_bf16 v[48:51], v[192:195], v[156:159], v[48:51]
    ds_read_b128 v[124:127], v200 offset:10240
    v_mfma_f32_16x16x32_bf16 v[84:87], v[156:159], v[196:199], v[84:87]
    ds_read_b128 v[128:131], v200 offset:12288
    v_mfma_f32_16x16x32_bf16 v[16:19], v[188:191], v[160:163], v[16:19]
    ds_read_b128 v[132:135], v200 offset:14336
    v_mfma_f32_16x16x32_bf16 v[52:55], v[192:195], v[160:163], v[52:55]
    ds_read_b128 v[136:139], v200 offset:16384
    v_mfma_f32_16x16x32_bf16 v[88:91], v[160:163], v[196:199], v[88:91]
    v_mfma_f32_16x16x32_bf16 v[20:23], v[188:191], v[164:167], v[20:23]
    v_mfma_f32_16x16x32_bf16 v[56:59], v[192:195], v[164:167], v[56:59]
    v_mfma_f32_16x16x32_bf16 v[92:95], v[164:167], v[196:199], v[92:95]
    v_mfma_f32_16x16x32_bf16 v[24:27], v[188:191], v[168:171], v[24:27]
    v_mfma_f32_16x16x32_bf16 v[60:63], v[192:195], v[168:171], v[60:63]
    v_mfma_f32_16x16x32_bf16 v[96:99], v[168:171], v[196:199], v[96:99]
    v_mfma_f32_16x16x32_bf16 v[28:31], v[188:191], v[172:175], v[28:31]
    v_mfma_f32_16x16x32_bf16 v[64:67], v[192:195], v[172:175], v[64:67]
    v_mfma_f32_16x16x32_bf16 v[100:103], v[172:175], v[196:199], v[100:103]
    v_add_u32 v201, s17, v204
    s_cmp_lt_u32 s18, 7
    s_cbranch_scc1 k1_loopB
    s_waitcnt lgkmcnt(0)
    v_mfma_f32_16x16x32_bf16 v[0:3], v[176:179], v[108:111], v[0:3]
    ds_read_b64_tr_b16 v[188:189], v202 offset:4096
    v_mfma_f32_16x16x32_bf16 v[36:39], v[180:183], v[108:111], v[36:39]
    ds_read_b64_tr_b16 v[190:191], v202 offset:4608
    v_mfma_f32_16x16x32_bf16 v[72:75], v[108:111], v[184:187], v[72:75]
    ds_read_b64_tr_b16 v[192:193], v202 offset:12288
    v_mfma_f32_16x16x32_bf16 v[4:7], v[176:179], v[112:115], v[4:7]
    ds_read_b64_tr_b16 v[194:195], v202 offset:12800
    v_mfma_f32_16x16x32_bf16 v[40:43], v[180:183], v[112:115], v[40:43]
    ds_read_b64_tr_b16 v[196:197], v202 offset:20480
    v_mfma_f32_16x16x32_bf16 v[76:79], v[112:115], v[184:187], v[76:79]
    ds_read_b64_tr_b16 v[198:199], v202 offset:20992
    v_mfma_f32_16x16x32_bf16 v[8:11], v[176:179], v[116:119], v[8:11]
    ds_read_b128 v[144:147], v201 offset:2048
    v_mfma_f32_16x16x32_bf16 v[44:47], v[180:183], v[116:119], v[44:47]
    ds_read_b128 v[148:151], v201 offset:4096
    v_mfma_f32_16x16x32_bf16 v[80:83], v[116:119], v[184:187], v[80:83]
    ds_read_b128 v[152:155], v201 offset:6144
    v_mfma_f32_16x16x32_bf16 v[12:15], v[176:179], v[120:123], v[12:15]
    ds_read_b128 v[156:159], v201 offset:8192
    v_mfma_f32_16x16x32_bf16 v[48:51], v[180:183], v[120:123], v[48:51]
    ds_read_b128 v[160:163], v201 offset:10240
    v_mfma_f32_16x16x32_bf16 v[84:87], v[120:123], v[184:187], v[84:87]
    ds_read_b128 v[164:167], v201 offset:12288
    v_mfma_f32_16x16x32_bf16 v[16:19], v[176:179], v[124:127], v[16:19]
    ds_read_b128 v[168:171], v201 offset:14336
    v_mfma_f32_16x16x32_bf16 v[52:55], v[180:183], v[124:127], v[52:55]
    ds_read_b128 v[172:175], v201 offset:16384
    v_mfma_f32_16x16x32_bf16 v[88:91], v[124:127], v[184:187], v[88:91]
    v_mfma_f32_16x16x32_bf16 v[20:23], v[176:179], v[128:131], v[20:23]
    v_mfma_f32_16x16x32_bf16 v[56:59], v[180:183], v[128:131], v[56:59]
    v_mfma_f32_16x16x32_bf16 v[92:95], v[128:131], v[184:187], v[92:95]
    v_mfma_f32_16x16x32_bf16 v[24:27], v[176:179], v[132:135], v[24:27]
    v_mfma_f32_16x16x32_bf16 v[60:63], v[180:183], v[132:135], v[60:63]
    v_mfma_f32_16x16x32_bf16 v[96:99], v[132:135], v[184:187], v[96:99]
    v_mfma_f32_16x16x32_bf16 v[28:31], v[176:179], v[136:139], v[28:31]
    v_mfma_f32_16x16x32_bf16 v[64:67], v[180:183], v[136:139], v[64:67]
    v_mfma_f32_16x16x32_bf16 v[100:103], v[136:139], v[184:187], v[100:103]
    s_waitcnt vmcnt(0) lgkmcnt(0)
    v_mfma_f32_16x16x32_bf16 v[0:3], v[188:191], v[144:147], v[0:3]
    v_mfma_f32_16x16x32_bf16 v[36:39], v[192:195], v[144:147], v[36:39]
    v_mfma_f32_16x16x32_bf16 v[72:75], v[144:147], v[196:199], v[72:75]
    v_mfma_f32_16x16x32_bf16 v[4:7], v[188:191], v[148:151], v[4:7]
    v_mfma_f32_16x16x32_bf16 v[40:43], v[192:195], v[148:151], v[40:43]
    v_mfma_f32_16x16x32_bf16 v[76:79], v[148:151], v[196:199], v[76:79]
    v_mfma_f32_16x16x32_bf16 v[8:11], v[188:191], v[152:155], v[8:11]
    v_mfma_f32_16x16x32_bf16 v[44:47], v[192:195], v[152:155], v[44:47]
    v_mfma_f32_16x16x32_bf16 v[80:83], v[152:155], v[196:199], v[80:83]
    v_mfma_f32_16x16x32_bf16 v[12:15], v[188:191], v[156:159], v[12:15]
    v_cvt_pk_bf16_f32 v108, v36, v37
    v_cvt_pk_bf16_f32 v109, v38, v39
    v_mfma_f32_16x16x32_bf16 v[48:51], v[192:195], v[156:159], v[48:51]
    v_cvt_pk_bf16_f32 v110, v40, v41
    v_cvt_pk_bf16_f32 v111, v42, v43
    v_mfma_f32_16x16x32_bf16 v[84:87], v[156:159], v[196:199], v[84:87]
    v_cvt_pk_bf16_f32 v112, v72, v73
    v_cvt_pk_bf16_f32 v113, v74, v75
    v_mfma_f32_16x16x32_bf16 v[16:19], v[188:191], v[160:163], v[16:19]
    v_cvt_pk_bf16_f32 v114, v76, v77
    v_cvt_pk_bf16_f32 v115, v78, v79
    v_mfma_f32_16x16x32_bf16 v[52:55], v[192:195], v[160:163], v[52:55]
    v_pk_mul_f32 v[0:1], v[0:1], s[36:37]
    v_pk_mul_f32 v[2:3], v[2:3], s[36:37]
    v_mfma_f32_16x16x32_bf16 v[88:91], v[160:163], v[196:199], v[88:91]
    v_pk_mul_f32 v[4:5], v[4:5], s[36:37]
    v_pk_mul_f32 v[6:7], v[6:7], s[36:37]
    v_mfma_f32_16x16x32_bf16 v[20:23], v[188:191], v[164:167], v[20:23]
    v_cvt_pk_bf16_f32 v104, v0, v1
    v_cvt_pk_bf16_f32 v105, v2, v3
    v_mfma_f32_16x16x32_bf16 v[56:59], v[192:195], v[164:167], v[56:59]
    v_cvt_pk_bf16_f32 v106, v4, v5
    v_cvt_pk_bf16_f32 v107, v6, v7
    v_mfma_f32_16x16x32_bf16 v[92:95], v[164:167], v[196:199], v[92:95]
    v_permlane16_swap_b32 v108, v110
    v_permlane16_swap_b32 v109, v111
    v_mfma_f32_16x16x32_bf16 v[24:27], v[188:191], v[168:171], v[24:27]
    v_permlane32_swap_b32 v112, v114
    v_permlane32_swap_b32 v113, v115
    v_mfma_f32_16x16x32_bf16 v[60:63], v[192:195], v[168:171], v[60:63]
    v_permlane16_swap_b32 v104, v106
    v_permlane16_swap_b32 v105, v107
    v_mfma_f32_16x16x32_bf16 v[96:99], v[168:171], v[196:199], v[96:99]
    buffer_store_dwordx4 v[108:111], v207, s[56:59], s34 offen offset:0 sc1
    buffer_store_dwordx4 v[112:115], v207, s[56:59], s34 offen offset:1024 sc1
    v_mfma_f32_16x16x32_bf16 v[28:31], v[188:191], v[172:175], v[28:31]
    buffer_store_dwordx4 v[104:107], v207, s[56:59], s32 offen sc1
    s_add_u32 s34, s34, 2048
    v_mfma_f32_16x16x32_bf16 v[64:67], v[192:195], v[172:175], v[64:67]
    s_add_u32 s32, s32, 1024
    v_cvt_pk_bf16_f32 v120, v44, v45
    v_mfma_f32_16x16x32_bf16 v[100:103], v[172:175], v[196:199], v[100:103]
    v_cvt_pk_bf16_f32 v121, v46, v47
    v_cvt_pk_bf16_f32 v122, v48, v49
    v_cvt_pk_bf16_f32 v123, v50, v51
    v_cvt_pk_bf16_f32 v124, v80, v81
    v_cvt_pk_bf16_f32 v125, v82, v83
    v_cvt_pk_bf16_f32 v126, v84, v85
    v_cvt_pk_bf16_f32 v127, v86, v87
    v_pk_mul_f32 v[8:9], v[8:9], s[36:37]
    v_pk_mul_f32 v[10:11], v[10:11], s[36:37]
    v_pk_mul_f32 v[12:13], v[12:13], s[36:37]
    v_pk_mul_f32 v[14:15], v[14:15], s[36:37]
    v_cvt_pk_bf16_f32 v116, v8, v9
    v_cvt_pk_bf16_f32 v117, v10, v11
    v_cvt_pk_bf16_f32 v118, v12, v13
    v_cvt_pk_bf16_f32 v119, v14, v15
    v_permlane16_swap_b32 v120, v122
    v_permlane16_swap_b32 v121, v123
    v_permlane32_swap_b32 v124, v126
    v_permlane32_swap_b32 v125, v127
    v_permlane16_swap_b32 v116, v118
    v_permlane16_swap_b32 v117, v119
    buffer_store_dwordx4 v[120:123], v207, s[56:59], s34 offen offset:0 sc1
    buffer_store_dwordx4 v[124:127], v207, s[56:59], s34 offen offset:1024 sc1
    buffer_store_dwordx4 v[116:119], v207, s[56:59], s32 offen sc1
    s_add_u32 s34, s34, 2048
    s_add_u32 s32, s32, 1024
    v_cvt_pk_bf16_f32 v132, v52, v53
    v_cvt_pk_bf16_f32 v133, v54, v55
    v_cvt_pk_bf16_f32 v134, v56, v57
    v_cvt_pk_bf16_f32 v135, v58, v59
    v_cvt_pk_bf16_f32 v136, v88, v89
    v_cvt_pk_bf16_f32 v137, v90, v91
    v_cvt_pk_bf16_f32 v138, v92, v93
    v_cvt_pk_bf16_f32 v139, v94, v95
    v_pk_mul_f32 v[16:17], v[16:17], s[36:37]
    v_pk_mul_f32 v[18:19], v[18:19], s[36:37]
    v_pk_mul_f32 v[20:21], v[20:21], s[36:37]
    v_pk_mul_f32 v[22:23], v[22:23], s[36:37]
    v_cvt_pk_bf16_f32 v128, v16, v17
    v_cvt_pk_bf16_f32 v129, v18, v19
    v_cvt_pk_bf16_f32 v130, v20, v21
    v_cvt_pk_bf16_f32 v131, v22, v23
    v_permlane16_swap_b32 v132, v134
    v_permlane16_swap_b32 v133, v135
    v_permlane32_swap_b32 v136, v138
    v_permlane32_swap_b32 v137, v139
    v_permlane16_swap_b32 v128, v130
    v_permlane16_swap_b32 v129, v131
    buffer_store_dwordx4 v[132:135], v207, s[56:59], s34 offen offset:0 sc1
    buffer_store_dwordx4 v[136:139], v207, s[56:59], s34 offen offset:1024 sc1
    buffer_store_dwordx4 v[128:131], v207, s[56:59], s32 offen sc1
    s_add_u32 s34, s34, 2048
    s_add_u32 s32, s32, 1024
    v_cvt_pk_bf16_f32 v180, v60, v61
    v_cvt_pk_bf16_f32 v181, v62, v63
    v_cvt_pk_bf16_f32 v182, v64, v65
    v_cvt_pk_bf16_f32 v183, v66, v67
    v_cvt_pk_bf16_f32 v184, v96, v97
    v_cvt_pk_bf16_f32 v185, v98, v99
    v_cvt_pk_bf16_f32 v186, v100, v101
    v_cvt_pk_bf16_f32 v187, v102, v103
    v_pk_mul_f32 v[24:25], v[24:25], s[36:37]
    v_pk_mul_f32 v[26:27], v[26:27], s[36:37]
    v_pk_mul_f32 v[28:29], v[28:29], s[36:37]
    v_pk_mul_f32 v[30:31], v[30:31], s[36:37]
    v_cvt_pk_bf16_f32 v176, v24, v25
    v_cvt_pk_bf16_f32 v177, v26, v27
    v_cvt_pk_bf16_f32 v178, v28, v29
    v_cvt_pk_bf16_f32 v179, v30, v31
    v_permlane16_swap_b32 v180, v182
    v_permlane16_swap_b32 v181, v183
    v_permlane32_swap_b32 v184, v186
    v_permlane32_swap_b32 v185, v187
    v_permlane16_swap_b32 v176, v178
    v_permlane16_swap_b32 v177, v179
    buffer_store_dwordx4 v[180:183], v207, s[56:59], s34 offen offset:0 sc1
    buffer_store_dwordx4 v[184:187], v207, s[56:59], s34 offen offset:1024 sc1
    buffer_store_dwordx4 v[176:179], v207, s[56:59], s32 offen sc1
    s_or_b32 s32, s13, s14
    s_or_b32 s32, s32, s15
    s_cmp_eq_u32 s32, 0
    s_cbranch_scc0 k1_noclr
    s_mov_b32 s32, 0xa00000
    v_mov_b32 v228, 0
    v_mov_b32 v229, 0
    v_mov_b32 v230, 0
    v_mov_b32 v231, 0
    buffer_store_dwordx4 v[228:231], v207, s[56:59], s32 offen sc1
    buffer_store_dwordx4 v[228:231], v207, s[56:59], s32 offen offset:1024 sc1
k1_noclr:
    s_endpgm
k1_end:
    s_endpgm
.globl k2_attn_kernel
.p2align 8
.type k2_attn_kernel,@function
k2_attn_kernel:
    s_cmp_ge_u32 s2, 256
    s_cbranch_scc1 k3_entry
    s_load_dwordx2 s[8:9], s[0:1], 64
    s_lshr_b32 s30, s2, 7
    s_mul_i32 s30, s30, 24
    s_add_u32 s30, s0, s30
    s_addc_u32 s31, s1, 0
    s_load_dwordx2 s[32:33], s[30:31], 16
    v_lshrrev_b32 v5, 6, v0
    v_and_b32 v8, 63, v0
    s_mov_b32 s10, 0xa01000
    s_mov_b32 s11, 0x00020000
    s_and_b32 s12, s2, 31
    v_readfirstlane_b32 s14, v5
    s_lshr_b32 s13, s2, 5
    v_lshlrev_b32 v4, 4, v8
    s_lshl_b32 s20, s12, 16
    s_lshl_b32 s21, s13, 3
    s_add_u32 s21, s21, s14
    s_lshl_b32 s22, s21, 10
    s_add_u32 s22, s22, s20
    s_add_u32 s22, s22, 0x400000
    s_lshl_b32 s23, s14, 10
    s_lshl_b32 s15, s12, 17
    s_add_u32 s15, s15, s23
    s_mov_b32 m0, s23
    s_waitcnt lgkmcnt(0)
    buffer_load_dwordx4 v4, s[8:11], s15 offen lds
    s_add_u32 m0, m0, 8192
    buffer_load_dwordx4 v[80:83], v4, s[8:11], s22 offen
    s_add_u32 s15, s15, 8192
    buffer_load_dwordx4 v4, s[8:11], s15 offen lds
    s_add_u32 m0, m0, 8192
    s_add_u32 s15, s15, 8192
    buffer_load_dwordx4 v4, s[8:11], s15 offen lds
    s_add_u32 m0, m0, 8192
    s_add_u32 s15, s15, 8192
    buffer_load_dwordx4 v4, s[8:11], s15 offen lds
    s_add_u32 m0, m0, 8192
    s_add_u32 s15, s15, 8192
    v_lshlrev_b32 v5, 4, v0
    v_add_u32 v5, 0x20000, v5
    v_mov_b32 v12, 0x3f803f80
    v_mov_b32 v13, 0x3f803f80
    v_mov_b32 v14, 0x3f803f80
    v_mov_b32 v15, 0x3f803f80
    ds_write_b128 v5, v[12:15]
    v_and_b32 v9, 15, v8
    v_lshlrev_b32 v9, 4, v9
    v_lshrrev_b32 v10, 5, v8
    v_lshlrev_b32 v10, 8, v10
    v_add_u32 v10, v10, v9
    v_add_u32 v10, 3072, v10
    v_add_u32 v9, 0x20000, v9
    v_and_b32 v11, 16, v8
    v_cmp_eq_u32 vcc, 0, v11
    v_mov_b32 v12, 0
    v_mov_b32 v13, 8192
    v_cndmask_b32 v7, v9, v10, vcc
    v_cndmask_b32 v3, v12, v13, vcc
    v_mov_b32 v6, v4
    s_mov_b32 s18, 0
    s_mov_b32 s17, 0
    s_lshl_b32 s24, s21, 15
    s_lshl_b32 s25, s12, 10
    s_add_u32 s24, s24, s25
    s_add_u32 s24, s24, 0x800000
    s_mov_b32 s26, 0x5f800000
    s_mov_b32 s34, 0x80000
    s_mov_b32 s35, 0x00020000
    s_lshr_b32 s31, s2, 3
    s_and_b32 s30, s31, 15
    s_lshl_b32 s30, s30, 15
    s_lshl_b32 s27, s14, 12
    s_add_u32 s30, s30, s27
    v_and_b32 v117, 31, v8
    v_lshlrev_b32 v117, 7, v117
    s_and_b32 s27, s2, 7
    s_lshl_b32 s27, s27, 18
    s_lshl_b32 s31, s31, 13
    s_add_u32 s31, s31, s27
    s_lshl_b32 s27, s14, 10
    s_add_u32 s31, s31, s27
    s_add_u32 s31, s31, 0x600000
    v_and_b32 v119, 7, v8
    v_lshlrev_b32 v119, 7, v119
    s_cmp_lt_u32 s14, 4
    s_cbranch_scc1 k2_prioA
    s_setprio 1
    s_branch k2_prioB
k2_prioA:
    s_setprio 2
k2_prioB:
    v_mov_b32 v112, 0
    v_mov_b32 v104, 0
    v_mov_b32 v113, 0
    v_mov_b32 v105, 0
    v_mov_b32 v114, 0
    v_mov_b32 v106, 0
    v_mov_b32 v115, 0
    v_mov_b32 v107, 0
    v_pk_mov_b32 v[64:65], v[112:113], v[112:113]
    v_pk_mov_b32 v[66:67], v[112:113], v[112:113]
    v_pk_mov_b32 v[68:69], v[112:113], v[112:113]
    v_pk_mov_b32 v[70:71], v[112:113], v[112:113]
    v_pk_mov_b32 v[72:73], v[112:113], v[112:113]
    v_pk_mov_b32 v[74:75], v[112:113], v[112:113]
    v_pk_mov_b32 v[76:77], v[112:113], v[112:113]
    v_pk_mov_b32 v[78:79], v[112:113], v[112:113]
    v_mov_b32 v1, v6
    v_mov_b32 v2, v7
    v_lshrrev_b32 v9, 2, v3
    v_sub_u32 v116, v7, v9
    s_mov_b32 s16, 0
    s_waitcnt vmcnt(3) lgkmcnt(0)
    s_barrier
    ds_read_b128 v[84:87], v6
    ds_read_b128 v[88:91], v6 offset:2048
    ds_read_b128 v[92:95], v116
    ds_read_b128 v[96:99], v116 offset:512
    s_waitcnt lgkmcnt(3)
    v_mfma_f32_32x32x16_bf16 v[16:31], v[84:87], v[80:83], 0
    s_nop 11
    v_max3_f32 v5, v16, v17, v18
    v_max3_f32 v9, v19, v20, v21
    v_max3_f32 v10, v22, v23, v24
    v_max3_f32 v11, v25, v26, v27
    v_max3_f32 v12, v28, v29, v30
    v_max3_f32 v5, v5, v9, v31
    v_max3_f32 v10, v10, v11, v12
    v_max_f32 v5, v5, v10
k2_pro2:
    v_mov_b32 v9, v5
    s_nop 1
    v_permlane32_swap_b32 v5, v9
    v_max_f32 v5, v5, v9
    v_sub_f32 v14, 0, v5
    v_sub_f32 v15, 0, v5
    v_pk_mov_b32 v[48:49], v[14:15], v[14:15]
    v_pk_mov_b32 v[50:51], v[14:15], v[14:15]
    v_pk_mov_b32 v[52:53], v[14:15], v[14:15]
    v_pk_mov_b32 v[54:55], v[14:15], v[14:15]
    v_pk_mov_b32 v[56:57], v[14:15], v[14:15]
    v_pk_mov_b32 v[58:59], v[14:15], v[14:15]
    v_pk_mov_b32 v[60:61], v[14:15], v[14:15]
    v_pk_mov_b32 v[62:63], v[14:15], v[14:15]
    s_waitcnt lgkmcnt(0)
    s_nop 0
    v_mfma_f32_32x32x16_bf16 v[16:31], v[84:87], v[80:83], v[48:63]
    s_nop 7
    s_nop 7
    s_cmp_eq_u32 s18, 1
    s_cbranch_scc1 k2_loop
    s_waitcnt vmcnt(2)
    s_barrier
    s_mov_b32 s17, 1
k2_loopl:
    s_cmp_eq_u32 s16, s17
    s_cbranch_scc1 k2_sync
k2_backl:
    s_waitcnt lgkmcnt(0)
    v_mfma_f32_32x32x16_bf16 v[32:47], v[88:91], v[80:83], v[48:63]
    ds_read_b128 v[84:87], v1 offset:4096
    ds_read_b128 v[100:103], v2 offset:0
    v_exp_f32 v16, v16
    v_exp_f32 v17, v17
    v_exp_f32 v18, v18
    v_exp_f32 v19, v19
    v_mfma_f32_32x32x16_bf16 v[64:79], v[104:107], v[112:115], v[64:79]
    ds_read_b128 v[104:107], v2 offset:512
    buffer_load_dwordx4 v4, s[8:11], s15 offen lds
    s_add_u32 m0, m0, 8192
    s_add_u32 s15, s15, 8192
    v_exp_f32 v20, v20
    v_exp_f32 v21, v21
    v_exp_f32 v22, v22
    v_exp_f32 v23, v23
    v_exp_f32 v24, v24
    v_cvt_pk_bf16_f32 v108, v16, v17
    v_cvt_pk_bf16_f32 v109, v18, v19
    v_cvt_pk_bf16_f32 v110, v20, v21
    v_cvt_pk_bf16_f32 v111, v22, v23
    v_exp_f32 v25, v25
    v_exp_f32 v26, v26
    v_mfma_f32_32x32x16_bf16 v[64:79], v[92:95], v[108:111], v[64:79]
    v_exp_f32 v27, v27
    v_exp_f32 v28, v28
    v_exp_f32 v29, v29
    v_exp_f32 v30, v30
    v_exp_f32 v31, v31
    v_cvt_pk_bf16_f32 v112, v24, v25
    v_cvt_pk_bf16_f32 v113, v26, v27
    v_cvt_pk_bf16_f32 v114, v28, v29
    v_cvt_pk_bf16_f32 v115, v30, v31
    s_waitcnt lgkmcnt(0)
    v_mfma_f32_32x32x16_bf16 v[16:31], v[84:87], v[80:83], v[48:63]
    ds_read_b128 v[88:91], v1 offset:6144
    ds_read_b128 v[92:95], v2 offset:2048
    v_exp_f32 v32, v32
    v_exp_f32 v33, v33
    v_exp_f32 v34, v34
    v_exp_f32 v35, v35
    v_mfma_f32_32x32x16_bf16 v[64:79], v[96:99], v[112:115], v[64:79]
    ds_read_b128 v[96:99], v2 offset:2560
    buffer_load_dwordx4 v4, s[8:11], s15 offen lds
    s_add_u32 m0, m0, 8192
    s_add_u32 s15, s15, 8192
    v_exp_f32 v36, v36
    v_exp_f32 v37, v37
    v_exp_f32 v38, v38
    v_exp_f32 v39, v39
    v_exp_f32 v40, v40
    v_cvt_pk_bf16_f32 v108, v32, v33
    v_cvt_pk_bf16_f32 v109, v34, v35
    v_cvt_pk_bf16_f32 v110, v36, v37
    v_cvt_pk_bf16_f32 v111, v38, v39
    v_exp_f32 v41, v41
    v_exp_f32 v42, v42
    v_mfma_f32_32x32x16_bf16 v[64:79], v[100:103], v[108:111], v[64:79]
    v_exp_f32 v43, v43
    v_exp_f32 v44, v44
    v_exp_f32 v45, v45
    v_exp_f32 v46, v46
    v_exp_f32 v47, v47
    v_cvt_pk_bf16_f32 v112, v40, v41
    v_cvt_pk_bf16_f32 v113, v42, v43
    v_cvt_pk_bf16_f32 v114, v44, v45
    v_cvt_pk_bf16_f32 v115, v46, v47
    s_waitcnt lgkmcnt(0)
    v_mfma_f32_32x32x16_bf16 v[32:47], v[88:91], v[80:83], v[48:63]
    ds_read_b128 v[84:87], v1 offset:8192
    ds_read_b128 v[100:103], v2 offset:4096
    v_exp_f32 v16, v16
    v_exp_f32 v17, v17
    v_exp_f32 v18, v18
    v_exp_f32 v19, v19
    v_mfma_f32_32x32x16_bf16 v[64:79], v[104:107], v[112:115], v[64:79]
    ds_read_b128 v[104:107], v2 offset:4608
    buffer_load_dwordx4 v4, s[8:11], s15 offen lds
    s_add_u32 m0, m0, 8192
    s_add_u32 s15, s15, 8192
    v_exp_f32 v20, v20
    v_exp_f32 v21, v21
    v_exp_f32 v22, v22
    v_exp_f32 v23, v23
    v_exp_f32 v24, v24
    v_cvt_pk_bf16_f32 v108, v16, v17
    v_cvt_pk_bf16_f32 v109, v18, v19
    v_cvt_pk_bf16_f32 v110, v20, v21
    v_cvt_pk_bf16_f32 v111, v22, v23
    v_exp_f32 v25, v25
    v_exp_f32 v26, v26
    v_mfma_f32_32x32x16_bf16 v[64:79], v[92:95], v[108:111], v[64:79]
    v_exp_f32 v27, v27
    v_exp_f32 v28, v28
    v_exp_f32 v29, v29
    v_exp_f32 v30, v30
    v_exp_f32 v31, v31
    v_cvt_pk_bf16_f32 v112, v24, v25
    v_cvt_pk_bf16_f32 v113, v26, v27
    v_cvt_pk_bf16_f32 v114, v28, v29
    v_cvt_pk_bf16_f32 v115, v30, v31
    s_waitcnt lgkmcnt(0)
    v_mfma_f32_32x32x16_bf16 v[16:31], v[84:87], v[80:83], v[48:63]
    ds_read_b128 v[88:91], v1 offset:10240
    ds_read_b128 v[92:95], v2 offset:6144
    v_exp_f32 v32, v32
    v_exp_f32 v33, v33
    v_exp_f32 v34, v34
    v_exp_f32 v35, v35
    v_mfma_f32_32x32x16_bf16 v[64:79], v[96:99], v[112:115], v[64:79]
    ds_read_b128 v[96:99], v2 offset:6656
    buffer_load_dwordx4 v4, s[8:11], s15 offen lds
    s_add_u32 m0, m0, 8192
    s_add_u32 s15, s15, 8192
    v_exp_f32 v36, v36
    v_exp_f32 v37, v37
    v_exp_f32 v38, v38
    v_exp_f32 v39, v39
    v_exp_f32 v40, v40
    v_cvt_pk_bf16_f32 v108, v32, v33
    v_cvt_pk_bf16_f32 v109, v34, v35
    v_cvt_pk_bf16_f32 v110, v36, v37
    v_cvt_pk_bf16_f32 v111, v38, v39
    v_exp_f32 v41, v41
    v_exp_f32 v42, v42
    v_mfma_f32_32x32x16_bf16 v[64:79], v[100:103], v[108:111], v[64:79]
    v_add_u32 v1, 8192, v1
    v_add_u32 v2, v2, v3
    v_exp_f32 v43, v43
    v_exp_f32 v44, v44
    v_exp_f32 v45, v45
    v_exp_f32 v46, v46
    v_exp_f32 v47, v47
    s_add_u32 s16, s16, 1
    s_cmp_lt_u32 s16, 3
    v_cvt_pk_bf16_f32 v112, v40, v41
    v_cvt_pk_bf16_f32 v113, v42, v43
    v_cvt_pk_bf16_f32 v114, v44, v45
    v_cvt_pk_bf16_f32 v115, v46, v47
    s_cbranch_scc1 k2_loopl
k2_loop:
    s_cmp_eq_u32 s16, s17
    s_cbranch_scc1 k2_sync
k2_back:
    s_waitcnt lgkmcnt(0)
    v_mfma_f32_32x32x16_bf16 v[32:47], v[88:91], v[80:83], v[48:63]
    ds_read_b128 v[84:87], v1 offset:4096
    ds_read_b128 v[100:103], v2 offset:0
    v_exp_f32 v16, v16
    v_exp_f32 v17, v17
    v_exp_f32 v18, v18
    v_exp_f32 v19, v19
    v_mfma_f32_32x32x16_bf16 v[64:79], v[104:107], v[112:115], v[64:79]
    ds_read_b128 v[104:107], v2 offset:512
    v_exp_f32 v20, v20
    v_exp_f32 v21, v21
    v_exp_f32 v22, v22
    v_exp_f32 v23, v23
    v_exp_f32 v24, v24
    v_cvt_pk_bf16_f32 v108, v16, v17
    v_cvt_pk_bf16_f32 v109, v18, v19
    v_cvt_pk_bf16_f32 v110, v20, v21
    v_cvt_pk_bf16_f32 v111, v22, v23
    v_exp_f32 v25, v25
    v_exp_f32 v26, v26
    v_mfma_f32_32x32x16_bf16 v[64:79], v[92:95], v[108:111], v[64:79]
    v_exp_f32 v27, v27
    v_exp_f32 v28, v28
    v_exp_f32 v29, v29
    v_exp_f32 v30, v30
    v_exp_f32 v31, v31
    v_cvt_pk_bf16_f32 v112, v24, v25
    v_cvt_pk_bf16_f32 v113, v26, v27
    v_cvt_pk_bf16_f32 v114, v28, v29
    v_cvt_pk_bf16_f32 v115, v30, v31
    s_waitcnt lgkmcnt(0)
    v_mfma_f32_32x32x16_bf16 v[16:31], v[84:87], v[80:83], v[48:63]
    ds_read_b128 v[88:91], v1 offset:6144
    ds_read_b128 v[92:95], v2 offset:2048
    v_exp_f32 v32, v32
    v_exp_f32 v33, v33
    v_exp_f32 v34, v34
    v_exp_f32 v35, v35
    v_mfma_f32_32x32x16_bf16 v[64:79], v[96:99], v[112:115], v[64:79]
    ds_read_b128 v[96:99], v2 offset:2560
    v_exp_f32 v36, v36
    v_exp_f32 v37, v37
    v_exp_f32 v38, v38
    v_exp_f32 v39, v39
    v_exp_f32 v40, v40
    v_cvt_pk_bf16_f32 v108, v32, v33
    v_cvt_pk_bf16_f32 v109, v34, v35
    v_cvt_pk_bf16_f32 v110, v36, v37
    v_cvt_pk_bf16_f32 v111, v38, v39
    v_exp_f32 v41, v41
    v_exp_f32 v42, v42
    v_mfma_f32_32x32x16_bf16 v[64:79], v[100:103], v[108:111], v[64:79]
    v_exp_f32 v43, v43
    v_exp_f32 v44, v44
    v_exp_f32 v45, v45
    v_exp_f32 v46, v46
    v_exp_f32 v47, v47
    v_cvt_pk_bf16_f32 v112, v40, v41
    v_cvt_pk_bf16_f32 v113, v42, v43
    v_cvt_pk_bf16_f32 v114, v44, v45
    v_cvt_pk_bf16_f32 v115, v46, v47
    s_waitcnt lgkmcnt(0)
    v_mfma_f32_32x32x16_bf16 v[32:47], v[88:91], v[80:83], v[48:63]
    ds_read_b128 v[84:87], v1 offset:8192
    ds_read_b128 v[100:103], v2 offset:4096
    v_exp_f32 v16, v16
    v_exp_f32 v17, v17
    v_exp_f32 v18, v18
    v_exp_f32 v19, v19
    v_mfma_f32_32x32x16_bf16 v[64:79], v[104:107], v[112:115], v[64:79]
    ds_read_b128 v[104:107], v2 offset:4608
    v_exp_f32 v20, v20
    v_exp_f32 v21, v21
    v_exp_f32 v22, v22
    v_exp_f32 v23, v23
    v_exp_f32 v24, v24
    v_cvt_pk_bf16_f32 v108, v16, v17
    v_cvt_pk_bf16_f32 v109, v18, v19
    v_cvt_pk_bf16_f32 v110, v20, v21
    v_cvt_pk_bf16_f32 v111, v22, v23
    v_exp_f32 v25, v25
    v_exp_f32 v26, v26
    v_mfma_f32_32x32x16_bf16 v[64:79], v[92:95], v[108:111], v[64:79]
    v_exp_f32 v27, v27
    v_exp_f32 v28, v28
    v_exp_f32 v29, v29
    v_exp_f32 v30, v30
    v_exp_f32 v31, v31
    v_cvt_pk_bf16_f32 v112, v24, v25
    v_cvt_pk_bf16_f32 v113, v26, v27
    v_cvt_pk_bf16_f32 v114, v28, v29
    v_cvt_pk_bf16_f32 v115, v30, v31
    s_waitcnt lgkmcnt(0)
    v_mfma_f32_32x32x16_bf16 v[16:31], v[84:87], v[80:83], v[48:63]
    ds_read_b128 v[88:91], v1 offset:10240
    ds_read_b128 v[92:95], v2 offset:6144
    v_exp_f32 v32, v32
    v_exp_f32 v33, v33
    v_exp_f32 v34, v34
    v_exp_f32 v35, v35
    v_mfma_f32_32x32x16_bf16 v[64:79], v[96:99], v[112:115], v[64:79]
    ds_read_b128 v[96:99], v2 offset:6656
    v_exp_f32 v36, v36
    v_exp_f32 v37, v37
    v_exp_f32 v38, v38
    v_exp_f32 v39, v39
    v_exp_f32 v40, v40
    v_cvt_pk_bf16_f32 v108, v32, v33
    v_cvt_pk_bf16_f32 v109, v34, v35
    v_cvt_pk_bf16_f32 v110, v36, v37
    v_cvt_pk_bf16_f32 v111, v38, v39
    v_exp_f32 v41, v41
    v_exp_f32 v42, v42
    v_mfma_f32_32x32x16_bf16 v[64:79], v[100:103], v[108:111], v[64:79]
    v_add_u32 v1, 8192, v1
    v_add_u32 v2, v2, v3
    v_exp_f32 v43, v43
    v_exp_f32 v44, v44
    v_exp_f32 v45, v45
    v_exp_f32 v46, v46
    v_exp_f32 v47, v47
    s_add_u32 s16, s16, 1
    s_cmp_lt_u32 s16, 16
    v_cvt_pk_bf16_f32 v112, v40, v41
    v_cvt_pk_bf16_f32 v113, v42, v43
    v_cvt_pk_bf16_f32 v114, v44, v45
    v_cvt_pk_bf16_f32 v115, v46, v47
    s_cbranch_scc1 k2_loop
    s_nop 0
    v_mfma_f32_32x32x16_bf16 v[64:79], v[104:107], v[112:115], v[64:79]
    s_waitcnt lgkmcnt(0)
    s_nop 10
    v_rcp_f32 v9, v72
    v_mov_b32 v10, 0
    v_fma_f32 v10, v64, 0, v10
    v_fma_f32 v10, v65, 0, v10
    v_fma_f32 v10, v66, 0, v10
    v_fma_f32 v10, v67, 0, v10
    v_fma_f32 v10, v68, 0, v10
    v_fma_f32 v10, v69, 0, v10
    v_fma_f32 v10, v70, 0, v10
    v_fma_f32 v10, v71, 0, v10
    v_cmp_gt_f32 vcc, s26, v72
    v_cmp_eq_f32 s[28:29], 0, v10
    s_nop 0
    s_and_b64 vcc, vcc, s[28:29]
    s_cmp_eq_u64 vcc, -1
    s_cbranch_scc0 k2_maxpass
k2_done:
    v_mul_f32 v64, v64, v9
    v_mul_f32 v65, v65, v9
    v_mul_f32 v66, v66, v9
    v_mul_f32 v67, v67, v9
    v_mul_f32 v68, v68, v9
    v_mul_f32 v69, v69, v9
    v_mul_f32 v70, v70, v9
    v_mul_f32 v71, v71, v9
    v_cvt_pk_bf16_f32 v108, v64, v65
    v_cvt_pk_bf16_f32 v109, v66, v67
    v_cvt_pk_bf16_f32 v110, v68, v69
    v_cvt_pk_bf16_f32 v111, v70, v71
    buffer_store_dwordx4 v[108:111], v4, s[8:11], s24 offen sc1
    s_lshl_b32 s24, s13, 8
    s_lshl_b32 s25, s12, 2
    s_add_u32 s24, s24, s25
    s_add_u32 s24, s24, 0xa00000
    v_mov_b32 v9, 1
    v_mov_b32 v10, 0
    s_waitcnt vmcnt(0)
    s_barrier
    s_cmp_eq_u32 s14, 0
    s_cbranch_scc0 k2_nosig
    s_mov_b64 exec, 1
    buffer_store_dword v9, v10, s[8:11], s24 offen sc1
k2_nosig:
    s_endpgm
k2_sync:
    s_cmp_eq_u32 s16, 1
    s_cbranch_scc1 k2_sync1
    s_cmp_eq_u32 s16, 3
    s_cbranch_scc1 k2_sync3
    s_cmp_eq_u32 s16, 6
    s_cbranch_scc1 k2_sync6
    s_cmp_eq_u32 s16, 0
    s_cbranch_scc1 k2_sync0
    s_mov_b32 s17, 99
    s_cmp_lt_u32 s14, 4
    s_cbranch_scc0 k2_back
    s_setprio 0
    s_branch k2_back
k2_sync0:
    s_waitcnt vmcnt(2)
    s_barrier
    s_mov_b32 s17, 1
    s_branch k2_backl
k2_sync1:
    s_waitcnt vmcnt(4)
    s_barrier
    s_mov_b32 s17, 3
    s_branch k2_backl
k2_sync3:
    s_waitcnt vmcnt(9)
    s_barrier
    s_mov_b32 s17, 6
    s_branch k2_back
k2_sync6:
    s_waitcnt vmcnt(0)
    s_barrier
    buffer_load_dword v118, v117, s[32:35], s30 offen
    buffer_load_dword v118, v119, s[8:11], s31 offen
    s_mov_b32 s17, 14
    s_branch k2_back
k2_maxpass:
    s_cmp_eq_u32 s18, 1
    s_cbranch_scc1 k2_done
    s_mov_b32 s18, 1
    s_mov_b32 s17, 99
    v_mov_b32 v5, 0xff800000
    v_mov_b32 v1, v6
    s_mov_b32 s16, 0
k2_maxloop:
    ds_read_b128 v[84:87], v1
    v_add_u32 v1, 2048, v1
    s_add_u32 s16, s16, 1
    s_cmp_lt_u32 s16, 64
    s_waitcnt lgkmcnt(0)
    v_mfma_f32_32x32x16_bf16 v[16:31], v[84:87], v[80:83], 0
    s_nop 11
    v_max3_f32 v5, v5, v16, v17
    v_max3_f32 v5, v5, v18, v19
    v_max3_f32 v5, v5, v20, v21
    v_max3_f32 v5, v5, v22, v23
    v_max3_f32 v5, v5, v24, v25
    v_max3_f32 v5, v5, v26, v27
    v_max3_f32 v5, v5, v28, v29
    v_max3_f32 v5, v5, v30, v31
    s_cbranch_scc1 k2_maxloop
    ds_read_b128 v[84:87], v6
    ds_read_b128 v[88:91], v6 offset:2048
    ds_read_b128 v[92:95], v116
    ds_read_b128 v[96:99], v116 offset:512
    v_mov_b32 v112, 0
    v_mov_b32 v104, 0
    v_mov_b32 v113, 0
    v_mov_b32 v105, 0
    v_mov_b32 v114, 0
    v_mov_b32 v106, 0
    v_mov_b32 v115, 0
    v_mov_b32 v107, 0
    v_pk_mov_b32 v[64:65], v[112:113], v[112:113]
    v_pk_mov_b32 v[66:67], v[112:113], v[112:113]
    v_pk_mov_b32 v[68:69], v[112:113], v[112:113]
    v_pk_mov_b32 v[70:71], v[112:113], v[112:113]
    v_pk_mov_b32 v[72:73], v[112:113], v[112:113]
    v_pk_mov_b32 v[74:75], v[112:113], v[112:113]
    v_pk_mov_b32 v[76:77], v[112:113], v[112:113]
    v_pk_mov_b32 v[78:79], v[112:113], v[112:113]
    v_mov_b32 v1, v6
    v_mov_b32 v2, v7
    s_mov_b32 s16, 0
    s_branch k2_pro2
k2_end:
    s_endpgm
k3_entry:
    s_cmp_ge_u32 s2, 512
    s_cbranch_scc1 k3_end
    v_readfirstlane_b32 s3, v0
    s_sub_u32 s2, s2, 256
    s_cmp_ge_u32 s3, 256
    s_cbranch_scc1 k3_end
    s_and_b32 s20, s2, 7
    s_lshr_b32 s21, s2, 3
    s_and_b32 s21, s21, 15
    s_lshr_b32 s12, s2, 7
    s_mul_i32 s22, s12, 24
    s_add_u32 s4, s0, s22
    s_addc_u32 s5, s1, 0
    s_load_dwordx2 s[24:25], s[4:5], 16
    s_load_dwordx2 s[26:27], s[0:1], 48
    s_load_dwordx2 s[28:29], s[0:1], 64
    v_lshrrev_b32 v200, 6, v0
    v_and_b32 v196, 63, v0
    s_lshl_b32 s22, s20, 1
    v_readfirstlane_b32 s15, v200
    s_and_b32 s23, s21, 1
    s_add_u32 s13, s22, s23
    s_lshr_b32 s14, s21, 1
    v_lshlrev_b32 v197, 4, v196
    v_lshrrev_b32 v200, 3, v196
    v_bfe_u32 v201, v196, 4, 1
    v_lshlrev_b32 v201, 2, v201
    v_and_b32 v202, 7, v196
    v_xor_b32 v202, v202, v201
    v_lshlrev_b32 v202, 4, v202
    v_lshl_add_u32 v198, v200, 10, v202
    s_lshl_b32 s30, s13, 2
    s_add_u32 s30, s30, s15
    s_lshl_b32 s31, s30, 15
    s_lshl_b32 s32, s12, 21
    s_add_u32 s31, s31, s32
    s_add_u32 s31, s31, 0x600000
    s_lshl_b32 s33, s15, 13
    s_lshl_b32 s34, s14, 7
    s_add_u32 s33, s33, s34
    s_lshl_b32 s34, s15, 10
    s_mov_b32 m0, s34
    s_waitcnt lgkmcnt(0)
    s_mov_b32 s4, s24
    s_mov_b32 s5, s25
    s_mov_b32 s6, 0x80000
    s_mov_b32 s7, 0x00020000
    s_mov_b32 s8, s28
    s_mov_b32 s9, s29
    s_mov_b32 s10, 0xa01000
    s_mov_b32 s11, 0x00020000
    s_mov_b32 s16, s26
    s_mov_b32 s17, s27
    s_mov_b32 s18, 0x400000
    s_mov_b32 s19, 0x00020000
    s_cmp_eq_u32 s12, 1
    s_cbranch_scc1 k3_B
    buffer_load_dwordx4 v198, s[4:7], s33 offen lds
    s_add_u32 m0, m0, 4096
    s_add_u32 s33, s33, 32768
    buffer_load_dwordx4 v[0:3], v197, s[8:11], s31 offen
    s_add_u32 s31, s31, 1024
    buffer_load_dwordx4 v[4:7], v197, s[8:11], s31 offen
    s_add_u32 s31, s31, 1024
    buffer_load_dwordx4 v198, s[4:7], s33 offen lds
    s_add_u32 m0, m0, 4096
    s_add_u32 s33, s33, 32768
    buffer_load_dwordx4 v[8:11], v197, s[8:11], s31 offen
    s_add_u32 s31, s31, 1024
    buffer_load_dwordx4 v[12:15], v197, s[8:11], s31 offen
    s_add_u32 s31, s31, 1024
    buffer_load_dwordx4 v198, s[4:7], s33 offen lds
    s_add_u32 m0, m0, 4096
    s_add_u32 s33, s33, 32768
    buffer_load_dwordx4 v[16:19], v197, s[8:11], s31 offen
    s_add_u32 s31, s31, 1024
    buffer_load_dwordx4 v[20:23], v197, s[8:11], s31 offen
    s_add_u32 s31, s31, 1024
    buffer_load_dwordx4 v198, s[4:7], s33 offen lds
    s_add_u32 m0, m0, 4096
    s_add_u32 s33, s33, 32768
    buffer_load_dwordx4 v[24:27], v197, s[8:11], s31 offen
    s_add_u32 s31, s31, 1024
    buffer_load_dwordx4 v[28:31], v197, s[8:11], s31 offen
    s_add_u32 s31, s31, 1024
    buffer_load_dwordx4 v198, s[4:7], s33 offen lds
    s_add_u32 m0, m0, 4096
    s_add_u32 s33, s33, 32768
    buffer_load_dwordx4 v[32:35], v197, s[8:11], s31 offen
    s_add_u32 s31, s31, 1024
    buffer_load_dwordx4 v[36:39], v197, s[8:11], s31 offen
    s_add_u32 s31, s31, 1024
    buffer_load_dwordx4 v198, s[4:7], s33 offen lds
    s_add_u32 m0, m0, 4096
    s_add_u32 s33, s33, 32768
    buffer_load_dwordx4 v[40:43], v197, s[8:11], s31 offen
    s_add_u32 s31, s31, 1024
    buffer_load_dwordx4 v[44:47], v197, s[8:11], s31 offen
    s_add_u32 s31, s31, 1024
    buffer_load_dwordx4 v198, s[4:7], s33 offen lds
    s_add_u32 m0, m0, 4096
    s_add_u32 s33, s33, 32768
    buffer_load_dwordx4 v[48:51], v197, s[8:11], s31 offen
    s_add_u32 s31, s31, 1024
    buffer_load_dwordx4 v[52:55], v197, s[8:11], s31 offen
    s_add_u32 s31, s31, 1024
    buffer_load_dwordx4 v198, s[4:7], s33 offen lds
    s_add_u32 m0, m0, 4096
    s_add_u32 s33, s33, 32768
    buffer_load_dwordx4 v[56:59], v197, s[8:11], s31 offen
    s_add_u32 s31, s31, 1024
    buffer_load_dwordx4 v[60:63], v197, s[8:11], s31 offen
    s_add_u32 s31, s31, 1024
    v_lshrrev_b32 v200, 5, v196
    s_sub_u32 s35, 3, s12
    v_lshlrev_b32 v200, s35, v200
    v_bfe_u32 v201, v196, 2, 2
    v_add_u32 v200, v200, v201
    v_lshlrev_b32 v200, 7, v200
    v_lshrrev_b32 v201, 1, v201
    v_lshl_add_u32 v200, v201, 6, v200
    v_bfe_u32 v201, v196, 4, 1
    v_lshl_add_u32 v200, v201, 5, v200
    v_and_b32 v201, 3, v196
    v_lshl_add_u32 v192, v201, 3, v200
    v_xor_b32 v194, 64, v192
    s_lshl_b32 s35, 512, s12
    v_add_u32 v193, s35, v192
    v_add_u32 v195, s35, v194
    v_lshrrev_b32 v200, 3, v196
    s_and_b32 s36, s30, 31
    s_lshl_b32 s36, s36, 5
    s_lshr_b32 s37, s30, 5
    v_add_u32 v201, s36, v200
    v_lshlrev_b32 v201, 1, v201
    v_add_u32 v201, s37, v201
    s_lshl_b32 s36, s30, 5
    v_add_u32 v200, s36, v200
    s_cmp_eq_u32 s12, 0
    s_cselect_b64 vcc, -1, 0
    v_cndmask_b32 v200, v200, v201, vcc
    v_lshlrev_b32 v200, 11, v200
    v_and_b32 v201, 7, v196
    v_lshl_add_u32 v199, v201, 4, v200
    s_lshr_b32 s40, 0x8000, s12
    s_lshl_b32 s41, s15, 12
    s_add_u32 s41, s41, 0x10000
    v_and_b32 v200, 31, v196
    v_lshrrev_b32 v201, 5, v196
    v_and_b32 v202, 7, v196
    v_xor_b32 v201, v201, v202
    v_lshlrev_b32 v201, 4, v201
    v_lshl_add_u32 v204, v200, 7, v201
    v_add_u32 v204, s41, v204
    v_lshrrev_b32 v200, 3, v196
    v_xor_b32 v201, v200, v202
    v_lshlrev_b32 v201, 4, v201
    v_lshl_add_u32 v205, v200, 7, v201
    v_add_u32 v205, s41, v205
    s_lshl_b32 s36, s12, 10
    s_lshl_b32 s37, s14, 7
    s_add_u32 s36, s36, s37
    v_mov_b32 v128, 0
    v_mov_b32 v129, 0
    v_mov_b32 v130, 0
    v_mov_b32 v131, 0
    v_mov_b32 v132, 0
    v_mov_b32 v133, 0
    v_mov_b32 v134, 0
    v_mov_b32 v135, 0
    v_mov_b32 v136, 0
    v_mov_b32 v137, 0
    v_mov_b32 v138, 0
    v_mov_b32 v139, 0
    v_mov_b32 v140, 0
    v_mov_b32 v141, 0
    v_mov_b32 v142, 0
    v_mov_b32 v143, 0
    v_mov_b32 v144, 0
    v_mov_b32 v145, 0
    v_mov_b32 v146, 0
    v_mov_b32 v147, 0
    v_mov_b32 v148, 0
    v_mov_b32 v149, 0
    v_mov_b32 v150, 0
    v_mov_b32 v151, 0
    v_mov_b32 v152, 0
    v_mov_b32 v153, 0
    v_mov_b32 v154, 0
    v_mov_b32 v155, 0
    v_mov_b32 v156, 0
    v_mov_b32 v157, 0
    v_mov_b32 v158, 0
    v_mov_b32 v159, 0
    s_waitcnt vmcnt(12)
    s_barrier
    ds_read_b64_tr_b16 v[160:161], v192 offset:0
    ds_read_b64_tr_b16 v[162:163], v193 offset:0
    ds_read_b64_tr_b16 v[164:165], v194 offset:0
    ds_read_b64_tr_b16 v[166:167], v195 offset:0
    ds_read_b64_tr_b16 v[168:169], v192 offset:2048
    ds_read_b64_tr_b16 v[170:171], v193 offset:2048
    ds_read_b64_tr_b16 v[172:173], v194 offset:2048
    ds_read_b64_tr_b16 v[174:175], v195 offset:2048
    s_waitcnt lgkmcnt(4)
    v_mfma_f32_32x32x16_bf16 v[128:143], v[160:163], v[0:3], v[128:143]
    ds_read_b64_tr_b16 v[176:177], v192 offset:4096
    ds_read_b64_tr_b16 v[178:179], v193 offset:4096
    buffer_load_dwordx4 v198, s[4:7], s33 offen lds
    s_add_u32 m0, m0, 4096
    s_add_u32 s33, s33, 32768
    v_mfma_f32_32x32x16_bf16 v[144:159], v[164:167], v[0:3], v[144:159]
    ds_read_b64_tr_b16 v[180:181], v194 offset:4096
    ds_read_b64_tr_b16 v[182:183], v195 offset:4096
    s_waitcnt lgkmcnt(4)
    v_mfma_f32_32x32x16_bf16 v[128:143], v[168:171], v[4:7], v[128:143]
    ds_read_b64_tr_b16 v[184:185], v192 offset:6144
    ds_read_b64_tr_b16 v[186:187], v193 offset:6144
    buffer_load_dwordx4 v[64:67], v197, s[8:11], s31 offen
    s_add_u32 s31, s31, 1024
    v_mfma_f32_32x32x16_bf16 v[144:159], v[172:175], v[4:7], v[144:159]
    ds_read_b64_tr_b16 v[188:189], v194 offset:6144
    ds_read_b64_tr_b16 v[190:191], v195 offset:6144
    buffer_load_dwordx4 v[68:71], v197, s[8:11], s31 offen
    s_add_u32 s31, s31, 1024
    s_waitcnt lgkmcnt(4)
    v_mfma_f32_32x32x16_bf16 v[128:143], v[176:179], v[8:11], v[128:143]
    ds_read_b64_tr_b16 v[160:161], v192 offset:8192
    ds_read_b64_tr_b16 v[162:163], v193 offset:8192
    buffer_load_dwordx4 v198, s[4:7], s33 offen lds
    s_add_u32 m0, m0, 4096
    s_add_u32 s33, s33, 32768
    v_mfma_f32_32x32x16_bf16 v[144:159], v[180:183], v[8:11], v[144:159]
    ds_read_b64_tr_b16 v[164:165], v194 offset:8192
    ds_read_b64_tr_b16 v[166:167], v195 offset:8192
    s_waitcnt lgkmcnt(4)
    v_mfma_f32_32x32x16_bf16 v[128:143], v[184:187], v[12:15], v[128:143]
    ds_read_b64_tr_b16 v[168:169], v192 offset:10240
    ds_read_b64_tr_b16 v[170:171], v193 offset:10240
    buffer_load_dwordx4 v[72:75], v197, s[8:11], s31 offen
    s_add_u32 s31, s31, 1024
    v_mfma_f32_32x32x16_bf16 v[144:159], v[188:191], v[12:15], v[144:159]
    ds_read_b64_tr_b16 v[172:173], v194 offset:10240
    ds_read_b64_tr_b16 v[174:175], v195 offset:10240
    buffer_load_dwordx4 v[76:79], v197, s[8:11], s31 offen
    s_add_u32 s31, s31, 1024
    s_waitcnt lgkmcnt(4)
    v_mfma_f32_32x32x16_bf16 v[128:143], v[160:163], v[16:19], v[128:143]
    ds_read_b64_tr_b16 v[176:177], v192 offset:12288
    ds_read_b64_tr_b16 v[178:179], v193 offset:12288
    buffer_load_dwordx4 v198, s[4:7], s33 offen lds
    s_add_u32 m0, m0, 4096
    s_add_u32 s33, s33, 32768
    v_mfma_f32_32x32x16_bf16 v[144:159], v[164:167], v[16:19], v[144:159]
    ds_read_b64_tr_b16 v[180:181], v194 offset:12288
    ds_read_b64_tr_b16 v[182:183], v195 offset:12288
    s_waitcnt lgkmcnt(4)
    v_mfma_f32_32x32x16_bf16 v[128:143], v[168:171], v[20:23], v[128:143]
    ds_read_b64_tr_b16 v[184:185], v192 offset:14336
    ds_read_b64_tr_b16 v[186:187], v193 offset:14336
    buffer_load_dwordx4 v[80:83], v197, s[8:11], s31 offen
    s_add_u32 s31, s31, 1024
    v_mfma_f32_32x32x16_bf16 v[144:159], v[172:175], v[20:23], v[144:159]
    ds_read_b64_tr_b16 v[188:189], v194 offset:14336
    ds_read_b64_tr_b16 v[190:191], v195 offset:14336
    buffer_load_dwordx4 v[84:87], v197, s[8:11], s31 offen
    s_add_u32 s31, s31, 1024
    s_waitcnt lgkmcnt(4)
    v_mfma_f32_32x32x16_bf16 v[128:143], v[176:179], v[24:27], v[128:143]
    buffer_load_dwordx4 v198, s[4:7], s33 offen lds
    s_add_u32 m0, m0, 4096
    s_add_u32 s33, s33, 32768
    v_mfma_f32_32x32x16_bf16 v[144:159], v[180:183], v[24:27], v[144:159]
    s_waitcnt lgkmcnt(0)
    v_mfma_f32_32x32x16_bf16 v[128:143], v[184:187], v[28:31], v[128:143]
    buffer_load_dwordx4 v[88:91], v197, s[8:11], s31 offen
    s_add_u32 s31, s31, 1024
    v_mfma_f32_32x32x16_bf16 v[144:159], v[188:191], v[28:31], v[144:159]
    buffer_load_dwordx4 v[92:95], v197, s[8:11], s31 offen
    s_add_u32 s31, s31, 1024
    s_waitcnt vmcnt(12)
    s_barrier
    ds_read_b64_tr_b16 v[160:161], v192 offset:16384
    ds_read_b64_tr_b16 v[162:163], v193 offset:16384
    ds_read_b64_tr_b16 v[164:165], v194 offset:16384
    ds_read_b64_tr_b16 v[166:167], v195 offset:16384
    ds_read_b64_tr_b16 v[168:169], v192 offset:18432
    ds_read_b64_tr_b16 v[170:171], v193 offset:18432
    ds_read_b64_tr_b16 v[172:173], v194 offset:18432
    ds_read_b64_tr_b16 v[174:175], v195 offset:18432
    s_waitcnt lgkmcnt(4)
    v_mfma_f32_32x32x16_bf16 v[128:143], v[160:163], v[32:35], v[128:143]
    ds_read_b64_tr_b16 v[176:177], v192 offset:20480
    ds_read_b64_tr_b16 v[178:179], v193 offset:20480
    buffer_load_dwordx4 v198, s[4:7], s33 offen lds
    s_add_u32 m0, m0, 4096
    s_add_u32 s33, s33, 32768
    v_mfma_f32_32x32x16_bf16 v[144:159], v[164:167], v[32:35], v[144:159]
    ds_read_b64_tr_b16 v[180:181], v194 offset:20480
    ds_read_b64_tr_b16 v[182:183], v195 offset:20480
    s_waitcnt lgkmcnt(4)
    v_mfma_f32_32x32x16_bf16 v[128:143], v[168:171], v[36:39], v[128:143]
    ds_read_b64_tr_b16 v[184:185], v192 offset:22528
    ds_read_b64_tr_b16 v[186:187], v193 offset:22528
    buffer_load_dwordx4 v[96:99], v197, s[8:11], s31 offen
    s_add_u32 s31, s31, 1024
    v_mfma_f32_32x32x16_bf16 v[144:159], v[172:175], v[36:39], v[144:159]
    ds_read_b64_tr_b16 v[188:189], v194 offset:22528
    ds_read_b64_tr_b16 v[190:191], v195 offset:22528
    buffer_load_dwordx4 v[100:103], v197, s[8:11], s31 offen
    s_add_u32 s31, s31, 1024
    s_waitcnt lgkmcnt(4)
    v_mfma_f32_32x32x16_bf16 v[128:143], v[176:179], v[40:43], v[128:143]
    ds_read_b64_tr_b16 v[160:161], v192 offset:24576
    ds_read_b64_tr_b16 v[162:163], v193 offset:24576
    buffer_load_dwordx4 v198, s[4:7], s33 offen lds
    s_add_u32 m0, m0, 4096
    s_add_u32 s33, s33, 32768
    v_mfma_f32_32x32x16_bf16 v[144:159], v[180:183], v[40:43], v[144:159]
    ds_read_b64_tr_b16 v[164:165], v194 offset:24576
    ds_read_b64_tr_b16 v[166:167], v195 offset:24576
    s_waitcnt lgkmcnt(4)
    v_mfma_f32_32x32x16_bf16 v[128:143], v[184:187], v[44:47], v[128:143]
    ds_read_b64_tr_b16 v[168:169], v192 offset:26624
    ds_read_b64_tr_b16 v[170:171], v193 offset:26624
    buffer_load_dwordx4 v[104:107], v197, s[8:11], s31 offen
    s_add_u32 s31, s31, 1024
    v_mfma_f32_32x32x16_bf16 v[144:159], v[188:191], v[44:47], v[144:159]
    ds_read_b64_tr_b16 v[172:173], v194 offset:26624
    ds_read_b64_tr_b16 v[174:175], v195 offset:26624
    buffer_load_dwordx4 v[108:111], v197, s[8:11], s31 offen
    s_add_u32 s31, s31, 1024
    s_waitcnt lgkmcnt(4)
    v_mfma_f32_32x32x16_bf16 v[128:143], v[160:163], v[48:51], v[128:143]
    ds_read_b64_tr_b16 v[176:177], v192 offset:28672
    ds_read_b64_tr_b16 v[178:179], v193 offset:28672
    buffer_load_dwordx4 v198, s[4:7], s33 offen lds
    s_add_u32 m0, m0, 4096
    s_add_u32 s33, s33, 32768
    v_mfma_f32_32x32x16_bf16 v[144:159], v[164:167], v[48:51], v[144:159]
    ds_read_b64_tr_b16 v[180:181], v194 offset:28672
    ds_read_b64_tr_b16 v[182:183], v195 offset:28672
    s_waitcnt lgkmcnt(4)
    v_mfma_f32_32x32x16_bf16 v[128:143], v[168:171], v[52:55], v[128:143]
    ds_read_b64_tr_b16 v[184:185], v192 offset:30720
    ds_read_b64_tr_b16 v[186:187], v193 offset:30720
    buffer_load_dwordx4 v[112:115], v197, s[8:11], s31 offen
    s_add_u32 s31, s31, 1024
    v_mfma_f32_32x32x16_bf16 v[144:159], v[172:175], v[52:55], v[144:159]
    ds_read_b64_tr_b16 v[188:189], v194 offset:30720
    ds_read_b64_tr_b16 v[190:191], v195 offset:30720
    buffer_load_dwordx4 v[116:119], v197, s[8:11], s31 offen
    s_add_u32 s31, s31, 1024
    s_waitcnt lgkmcnt(4)
    v_mfma_f32_32x32x16_bf16 v[128:143], v[176:179], v[56:59], v[128:143]
    buffer_load_dwordx4 v198, s[4:7], s33 offen lds
    s_add_u32 m0, m0, 4096
    s_add_u32 s33, s33, 32768
    v_mfma_f32_32x32x16_bf16 v[144:159], v[180:183], v[56:59], v[144:159]
    s_waitcnt lgkmcnt(0)
    v_mfma_f32_32x32x16_bf16 v[128:143], v[184:187], v[60:63], v[128:143]
    buffer_load_dwordx4 v[120:123], v197, s[8:11], s31 offen
    s_add_u32 s31, s31, 1024
    v_mfma_f32_32x32x16_bf16 v[144:159], v[188:191], v[60:63], v[144:159]
    buffer_load_dwordx4 v[124:127], v197, s[8:11], s31 offen
    s_add_u32 s31, s31, 1024
    s_waitcnt vmcnt(12)
    s_barrier
    ds_read_b64_tr_b16 v[160:161], v192 offset:32768
    ds_read_b64_tr_b16 v[162:163], v193 offset:32768
    ds_read_b64_tr_b16 v[164:165], v194 offset:32768
    ds_read_b64_tr_b16 v[166:167], v195 offset:32768
    ds_read_b64_tr_b16 v[168:169], v192 offset:34816
    ds_read_b64_tr_b16 v[170:171], v193 offset:34816
    ds_read_b64_tr_b16 v[172:173], v194 offset:34816
    ds_read_b64_tr_b16 v[174:175], v195 offset:34816
    s_waitcnt lgkmcnt(4)
    v_mfma_f32_32x32x16_bf16 v[128:143], v[160:163], v[64:67], v[128:143]
    ds_read_b64_tr_b16 v[176:177], v192 offset:36864
    ds_read_b64_tr_b16 v[178:179], v193 offset:36864
    v_mfma_f32_32x32x16_bf16 v[144:159], v[164:167], v[64:67], v[144:159]
    ds_read_b64_tr_b16 v[180:181], v194 offset:36864
    ds_read_b64_tr_b16 v[182:183], v195 offset:36864
    s_waitcnt lgkmcnt(4)
    v_mfma_f32_32x32x16_bf16 v[128:143], v[168:171], v[68:71], v[128:143]
    ds_read_b64_tr_b16 v[184:185], v192 offset:38912
    ds_read_b64_tr_b16 v[186:187], v193 offset:38912
    v_mfma_f32_32x32x16_bf16 v[144:159], v[172:175], v[68:71], v[144:159]
    ds_read_b64_tr_b16 v[188:189], v194 offset:38912
    ds_read_b64_tr_b16 v[190:191], v195 offset:38912
    s_waitcnt lgkmcnt(4)
    v_mfma_f32_32x32x16_bf16 v[128:143], v[176:179], v[72:75], v[128:143]
    ds_read_b64_tr_b16 v[160:161], v192 offset:40960
    ds_read_b64_tr_b16 v[162:163], v193 offset:40960
    v_mfma_f32_32x32x16_bf16 v[144:159], v[180:183], v[72:75], v[144:159]
    ds_read_b64_tr_b16 v[164:165], v194 offset:40960
    ds_read_b64_tr_b16 v[166:167], v195 offset:40960
    s_waitcnt lgkmcnt(4)
    v_mfma_f32_32x32x16_bf16 v[128:143], v[184:187], v[76:79], v[128:143]
    ds_read_b64_tr_b16 v[168:169], v192 offset:43008
    ds_read_b64_tr_b16 v[170:171], v193 offset:43008
    v_mfma_f32_32x32x16_bf16 v[144:159], v[188:191], v[76:79], v[144:159]
    ds_read_b64_tr_b16 v[172:173], v194 offset:43008
    ds_read_b64_tr_b16 v[174:175], v195 offset:43008
    s_waitcnt lgkmcnt(4)
    v_mfma_f32_32x32x16_bf16 v[128:143], v[160:163], v[80:83], v[128:143]
    ds_read_b64_tr_b16 v[176:177], v192 offset:45056
    ds_read_b64_tr_b16 v[178:179], v193 offset:45056
    v_mfma_f32_32x32x16_bf16 v[144:159], v[164:167], v[80:83], v[144:159]
    ds_read_b64_tr_b16 v[180:181], v194 offset:45056
    ds_read_b64_tr_b16 v[182:183], v195 offset:45056
    s_waitcnt lgkmcnt(4)
    v_mfma_f32_32x32x16_bf16 v[128:143], v[168:171], v[84:87], v[128:143]
    ds_read_b64_tr_b16 v[184:185], v192 offset:47104
    ds_read_b64_tr_b16 v[186:187], v193 offset:47104
    v_mfma_f32_32x32x16_bf16 v[144:159], v[172:175], v[84:87], v[144:159]
    ds_read_b64_tr_b16 v[188:189], v194 offset:47104
    ds_read_b64_tr_b16 v[190:191], v195 offset:47104
    s_waitcnt lgkmcnt(4)
    v_mfma_f32_32x32x16_bf16 v[128:143], v[176:179], v[88:91], v[128:143]
    v_mfma_f32_32x32x16_bf16 v[144:159], v[180:183], v[88:91], v[144:159]
    s_waitcnt lgkmcnt(0)
    v_mfma_f32_32x32x16_bf16 v[128:143], v[184:187], v[92:95], v[128:143]
    v_mfma_f32_32x32x16_bf16 v[144:159], v[188:191], v[92:95], v[144:159]
    s_waitcnt vmcnt(0)
    s_barrier
    ds_read_b64_tr_b16 v[160:161], v192 offset:49152
    ds_read_b64_tr_b16 v[162:163], v193 offset:49152
    ds_read_b64_tr_b16 v[164:165], v194 offset:49152
    ds_read_b64_tr_b16 v[166:167], v195 offset:49152
    ds_read_b64_tr_b16 v[168:169], v192 offset:51200
    ds_read_b64_tr_b16 v[170:171], v193 offset:51200
    ds_read_b64_tr_b16 v[172:173], v194 offset:51200
    ds_read_b64_tr_b16 v[174:175], v195 offset:51200
    s_waitcnt lgkmcnt(4)
    v_mfma_f32_32x32x16_bf16 v[128:143], v[160:163], v[96:99], v[128:143]
    ds_read_b64_tr_b16 v[176:177], v192 offset:53248
    ds_read_b64_tr_b16 v[178:179], v193 offset:53248
    v_mfma_f32_32x32x16_bf16 v[144:159], v[164:167], v[96:99], v[144:159]
    ds_read_b64_tr_b16 v[180:181], v194 offset:53248
    ds_read_b64_tr_b16 v[182:183], v195 offset:53248
    s_waitcnt lgkmcnt(4)
    v_mfma_f32_32x32x16_bf16 v[128:143], v[168:171], v[100:103], v[128:143]
    ds_read_b64_tr_b16 v[184:185], v192 offset:55296
    ds_read_b64_tr_b16 v[186:187], v193 offset:55296
    v_mfma_f32_32x32x16_bf16 v[144:159], v[172:175], v[100:103], v[144:159]
    ds_read_b64_tr_b16 v[188:189], v194 offset:55296
    ds_read_b64_tr_b16 v[190:191], v195 offset:55296
    s_waitcnt lgkmcnt(4)
    v_mfma_f32_32x32x16_bf16 v[128:143], v[176:179], v[104:107], v[128:143]
    ds_read_b64_tr_b16 v[160:161], v192 offset:57344
    ds_read_b64_tr_b16 v[162:163], v193 offset:57344
    v_mfma_f32_32x32x16_bf16 v[144:159], v[180:183], v[104:107], v[144:159]
    ds_read_b64_tr_b16 v[164:165], v194 offset:57344
    ds_read_b64_tr_b16 v[166:167], v195 offset:57344
    s_waitcnt lgkmcnt(4)
    v_mfma_f32_32x32x16_bf16 v[128:143], v[184:187], v[108:111], v[128:143]
    ds_read_b64_tr_b16 v[168:169], v192 offset:59392
    ds_read_b64_tr_b16 v[170:171], v193 offset:59392
    v_mfma_f32_32x32x16_bf16 v[144:159], v[188:191], v[108:111], v[144:159]
    ds_read_b64_tr_b16 v[172:173], v194 offset:59392
    ds_read_b64_tr_b16 v[174:175], v195 offset:59392
    s_waitcnt lgkmcnt(4)
    v_mfma_f32_32x32x16_bf16 v[128:143], v[160:163], v[112:115], v[128:143]
    ds_read_b64_tr_b16 v[176:177], v192 offset:61440
    ds_read_b64_tr_b16 v[178:179], v193 offset:61440
    v_mfma_f32_32x32x16_bf16 v[144:159], v[164:167], v[112:115], v[144:159]
    ds_read_b64_tr_b16 v[180:181], v194 offset:61440
    ds_read_b64_tr_b16 v[182:183], v195 offset:61440
    s_waitcnt lgkmcnt(4)
    v_mfma_f32_32x32x16_bf16 v[128:143], v[168:171], v[116:119], v[128:143]
    ds_read_b64_tr_b16 v[184:185], v192 offset:63488
    ds_read_b64_tr_b16 v[186:187], v193 offset:63488
    v_mfma_f32_32x32x16_bf16 v[144:159], v[172:175], v[116:119], v[144:159]
    ds_read_b64_tr_b16 v[188:189], v194 offset:63488
    ds_read_b64_tr_b16 v[190:191], v195 offset:63488
    s_waitcnt lgkmcnt(4)
    v_mfma_f32_32x32x16_bf16 v[128:143], v[176:179], v[120:123], v[128:143]
    v_mfma_f32_32x32x16_bf16 v[144:159], v[180:183], v[120:123], v[144:159]
    s_waitcnt lgkmcnt(0)
    v_mfma_f32_32x32x16_bf16 v[128:143], v[184:187], v[124:127], v[128:143]
    v_mfma_f32_32x32x16_bf16 v[144:159], v[188:191], v[124:127], v[144:159]
k3_epi:
    s_nop 10
    v_cvt_pk_bf16_f32 v0, v128, v129
    v_cvt_pk_bf16_f32 v1, v130, v131
    v_cvt_pk_bf16_f32 v2, v132, v133
    v_cvt_pk_bf16_f32 v3, v134, v135
    v_cvt_pk_bf16_f32 v4, v136, v137
    v_cvt_pk_bf16_f32 v5, v138, v139
    v_cvt_pk_bf16_f32 v6, v140, v141
    v_cvt_pk_bf16_f32 v7, v142, v143
    v_cvt_pk_bf16_f32 v8, v144, v145
    v_cvt_pk_bf16_f32 v9, v146, v147
    v_cvt_pk_bf16_f32 v10, v148, v149
    v_cvt_pk_bf16_f32 v11, v150, v151
    v_cvt_pk_bf16_f32 v12, v152, v153
    v_cvt_pk_bf16_f32 v13, v154, v155
    v_cvt_pk_bf16_f32 v14, v156, v157
    v_cvt_pk_bf16_f32 v15, v158, v159
    v_permlane32_swap_b32 v0, v2
    v_permlane32_swap_b32 v1, v3
    v_permlane32_swap_b32 v4, v6
    v_permlane32_swap_b32 v5, v7
    v_permlane32_swap_b32 v8, v10
    v_permlane32_swap_b32 v9, v11
    v_permlane32_swap_b32 v12, v14
    v_permlane32_swap_b32 v13, v15
    v_xor_b32 v201, 32, v204
    v_xor_b32 v202, 64, v204
    v_xor_b32 v203, 96, v204
    ds_write_b128 v204, v[0:3]
    ds_write_b128 v201, v[4:7]
    ds_write_b128 v202, v[8:11]
    ds_write_b128 v203, v[12:15]
    ds_read_b128 v[16:19], v205 offset:0
    ds_read_b128 v[20:23], v205 offset:1024
    ds_read_b128 v[24:27], v205 offset:2048
    ds_read_b128 v[28:31], v205 offset:3072
    s_waitcnt lgkmcnt(3)
    buffer_store_dwordx4 v[16:19], v199, s[16:19], s36 offen sc1
    s_add_u32 s36, s36, s40
    s_waitcnt lgkmcnt(2)
    buffer_store_dwordx4 v[20:23], v199, s[16:19], s36 offen sc1
    s_add_u32 s36, s36, s40
    s_waitcnt lgkmcnt(1)
    buffer_store_dwordx4 v[24:27], v199, s[16:19], s36 offen sc1
    s_add_u32 s36, s36, s40
    s_waitcnt lgkmcnt(0)
    buffer_store_dwordx4 v[28:31], v199, s[16:19], s36 offen sc1
k3_end:
    s_endpgm
k3_B:
    v_and_b32 v200, 31, v196
    v_lshlrev_b32 v202, 2, v200
    s_lshr_b32 s38, s13, 1
    s_lshl_b32 s38, s38, 8
    s_add_u32 s38, s38, 0xa00000
    s_mov_b32 s39, 0
    buffer_load_dword v203, v202, s[8:11], s38 offen sc1
    buffer_load_dwordx4 v198, s[4:7], s33 offen lds
    s_add_u32 m0, m0, 4096
    s_add_u32 s33, s33, 32768
    buffer_load_dwordx4 v198, s[4:7], s33 offen lds
    s_add_u32 m0, m0, 4096
    s_add_u32 s33, s33, 32768
    buffer_load_dwordx4 v198, s[4:7], s33 offen lds
    s_add_u32 m0, m0, 4096
    s_add_u32 s33, s33, 32768
    buffer_load_dwordx4 v198, s[4:7], s33 offen lds
    s_add_u32 m0, m0, 4096
    s_add_u32 s33, s33, 32768
    buffer_load_dwordx4 v198, s[4:7], s33 offen lds
    s_add_u32 m0, m0, 4096
    s_add_u32 s33, s33, 32768
    buffer_load_dwordx4 v198, s[4:7], s33 offen lds
    s_add_u32 m0, m0, 4096
    s_add_u32 s33, s33, 32768
    buffer_load_dwordx4 v198, s[4:7], s33 offen lds
    s_add_u32 m0, m0, 4096
    s_add_u32 s33, s33, 32768
    buffer_load_dwordx4 v198, s[4:7], s33 offen lds
    s_add_u32 m0, m0, 4096
    s_add_u32 s33, s33, 32768
    buffer_load_dwordx4 v198, s[4:7], s33 offen lds
    s_add_u32 m0, m0, 4096
    s_add_u32 s33, s33, 32768
    buffer_load_dwordx4 v198, s[4:7], s33 offen lds
    s_add_u32 m0, m0, 4096
    s_add_u32 s33, s33, 32768
    buffer_load_dwordx4 v198, s[4:7], s33 offen lds
    s_add_u32 m0, m0, 4096
    s_add_u32 s33, s33, 32768
    buffer_load_dwordx4 v198, s[4:7], s33 offen lds
    s_add_u32 m0, m0, 4096
    s_add_u32 s33, s33, 32768
    buffer_load_dwordx4 v198, s[4:7], s33 offen lds
    s_add_u32 m0, m0, 4096
    s_add_u32 s33, s33, 32768
    buffer_load_dwordx4 v198, s[4:7], s33 offen lds
    s_add_u32 m0, m0, 4096
    s_add_u32 s33, s33, 32768
    buffer_load_dwordx4 v198, s[4:7], s33 offen lds
    s_add_u32 m0, m0, 4096
    s_add_u32 s33, s33, 32768
    buffer_load_dwordx4 v198, s[4:7], s33 offen lds
    s_add_u32 m0, m0, 4096
    s_add_u32 s33, s33, 32768
    s_waitcnt vmcnt(16)
k3_chk:
    v_cmp_eq_u32 vcc, 1, v203
    s_add_u32 s39, s39, 1
    s_cmp_eq_u64 vcc, -1
    s_cbranch_scc1 k3_go
    s_cmp_ge_u32 s39, 0x100000
    s_cbranch_scc1 k3_go
    buffer_load_dword v203, v202, s[8:11], s38 offen sc1
    s_waitcnt vmcnt(0)
    s_branch k3_chk
k3_go:
    buffer_load_dwordx4 v[0:3], v197, s[8:11], s31 offen sc1
    s_add_u32 s31, s31, 1024
    buffer_load_dwordx4 v[4:7], v197, s[8:11], s31 offen sc1
    s_add_u32 s31, s31, 1024
    buffer_load_dwordx4 v[8:11], v197, s[8:11], s31 offen sc1
    s_add_u32 s31, s31, 1024
    buffer_load_dwordx4 v[12:15], v197, s[8:11], s31 offen sc1
    s_add_u32 s31, s31, 1024
    buffer_load_dwordx4 v[16:19], v197, s[8:11], s31 offen sc1
    s_add_u32 s31, s31, 1024
    buffer_load_dwordx4 v[20:23], v197, s[8:11], s31 offen sc1
    s_add_u32 s31, s31, 1024
    buffer_load_dwordx4 v[24:27], v197, s[8:11], s31 offen sc1
    s_add_u32 s31, s31, 1024
    buffer_load_dwordx4 v[28:31], v197, s[8:11], s31 offen sc1
    s_add_u32 s31, s31, 1024
    buffer_load_dwordx4 v[32:35], v197, s[8:11], s31 offen sc1
    s_add_u32 s31, s31, 1024
    buffer_load_dwordx4 v[36:39], v197, s[8:11], s31 offen sc1
    s_add_u32 s31, s31, 1024
    buffer_load_dwordx4 v[40:43], v197, s[8:11], s31 offen sc1
    s_add_u32 s31, s31, 1024
    buffer_load_dwordx4 v[44:47], v197, s[8:11], s31 offen sc1
    s_add_u32 s31, s31, 1024
    buffer_load_dwordx4 v[48:51], v197, s[8:11], s31 offen sc1
    s_add_u32 s31, s31, 1024
    buffer_load_dwordx4 v[52:55], v197, s[8:11], s31 offen sc1
    s_add_u32 s31, s31, 1024
    buffer_load_dwordx4 v[56:59], v197, s[8:11], s31 offen sc1
    s_add_u32 s31, s31, 1024
    buffer_load_dwordx4 v[60:63], v197, s[8:11], s31 offen sc1
    s_add_u32 s31, s31, 1024
    v_lshrrev_b32 v200, 5, v196
    s_sub_u32 s35, 3, s12
    v_lshlrev_b32 v200, s35, v200
    v_bfe_u32 v201, v196, 2, 2
    v_add_u32 v200, v200, v201
    v_lshlrev_b32 v200, 7, v200
    v_lshrrev_b32 v201, 1, v201
    v_lshl_add_u32 v200, v201, 6, v200
    v_bfe_u32 v201, v196, 4, 1
    v_lshl_add_u32 v200, v201, 5, v200
    v_and_b32 v201, 3, v196
    v_lshl_add_u32 v192, v201, 3, v200
    v_xor_b32 v194, 64, v192
    s_lshl_b32 s35, 512, s12
    v_add_u32 v193, s35, v192
    v_add_u32 v195, s35, v194
    v_lshrrev_b32 v200, 3, v196
    s_and_b32 s36, s30, 31
    s_lshl_b32 s36, s36, 5
    s_lshr_b32 s37, s30, 5
    v_add_u32 v201, s36, v200
    v_lshlrev_b32 v201, 1, v201
    v_add_u32 v201, s37, v201
    s_lshl_b32 s36, s30, 5
    v_add_u32 v200, s36, v200
    s_cmp_eq_u32 s12, 0
    s_cselect_b64 vcc, -1, 0
    v_cndmask_b32 v200, v200, v201, vcc
    v_lshlrev_b32 v200, 11, v200
    v_and_b32 v201, 7, v196
    v_lshl_add_u32 v199, v201, 4, v200
    s_lshr_b32 s40, 0x8000, s12
    s_lshl_b32 s41, s15, 12
    s_add_u32 s41, s41, 0x10000
    v_and_b32 v200, 31, v196
    v_lshrrev_b32 v201, 5, v196
    v_and_b32 v202, 7, v196
    v_xor_b32 v201, v201, v202
    v_lshlrev_b32 v201, 4, v201
    v_lshl_add_u32 v204, v200, 7, v201
    v_add_u32 v204, s41, v204
    v_lshrrev_b32 v200, 3, v196
    v_xor_b32 v201, v200, v202
    v_lshlrev_b32 v201, 4, v201
    v_lshl_add_u32 v205, v200, 7, v201
    v_add_u32 v205, s41, v205
    s_lshl_b32 s36, s12, 10
    s_lshl_b32 s37, s14, 7
    s_add_u32 s36, s36, s37
    v_mov_b32 v128, 0
    v_mov_b32 v129, 0
    v_mov_b32 v130, 0
    v_mov_b32 v131, 0
    v_mov_b32 v132, 0
    v_mov_b32 v133, 0
    v_mov_b32 v134, 0
    v_mov_b32 v135, 0
    v_mov_b32 v136, 0
    v_mov_b32 v137, 0
    v_mov_b32 v138, 0
    v_mov_b32 v139, 0
    v_mov_b32 v140, 0
    v_mov_b32 v141, 0
    v_mov_b32 v142, 0
    v_mov_b32 v143, 0
    v_mov_b32 v144, 0
    v_mov_b32 v145, 0
    v_mov_b32 v146, 0
    v_mov_b32 v147, 0
    v_mov_b32 v148, 0
    v_mov_b32 v149, 0
    v_mov_b32 v150, 0
    v_mov_b32 v151, 0
    v_mov_b32 v152, 0
    v_mov_b32 v153, 0
    v_mov_b32 v154, 0
    v_mov_b32 v155, 0
    v_mov_b32 v156, 0
    v_mov_b32 v157, 0
    v_mov_b32 v158, 0
    v_mov_b32 v159, 0
    s_waitcnt vmcnt(16)
    s_barrier
    ds_read_b64_tr_b16 v[160:161], v192 offset:0
    ds_read_b64_tr_b16 v[162:163], v193 offset:0
    ds_read_b64_tr_b16 v[164:165], v194 offset:0
    ds_read_b64_tr_b16 v[166:167], v195 offset:0
    ds_read_b64_tr_b16 v[168:169], v192 offset:2048
    ds_read_b64_tr_b16 v[170:171], v193 offset:2048
    ds_read_b64_tr_b16 v[172:173], v194 offset:2048
    ds_read_b64_tr_b16 v[174:175], v195 offset:2048
    s_waitcnt vmcnt(15) lgkmcnt(4)
    v_mfma_f32_32x32x16_bf16 v[128:143], v[160:163], v[0:3], v[128:143]
    ds_read_b64_tr_b16 v[176:177], v192 offset:4096
    ds_read_b64_tr_b16 v[178:179], v193 offset:4096
    buffer_load_dwordx4 v[64:67], v197, s[8:11], s31 offen sc1
    s_add_u32 s31, s31, 1024
    v_mfma_f32_32x32x16_bf16 v[144:159], v[164:167], v[0:3], v[144:159]
    ds_read_b64_tr_b16 v[180:181], v194 offset:4096
    ds_read_b64_tr_b16 v[182:183], v195 offset:4096
    s_waitcnt vmcnt(15) lgkmcnt(4)
    v_mfma_f32_32x32x16_bf16 v[128:143], v[168:171], v[4:7], v[128:143]
    ds_read_b64_tr_b16 v[184:185], v192 offset:6144
    ds_read_b64_tr_b16 v[186:187], v193 offset:6144
    buffer_load_dwordx4 v[68:71], v197, s[8:11], s31 offen sc1
    s_add_u32 s31, s31, 1024
    v_mfma_f32_32x32x16_bf16 v[144:159], v[172:175], v[4:7], v[144:159]
    ds_read_b64_tr_b16 v[188:189], v194 offset:6144
    ds_read_b64_tr_b16 v[190:191], v195 offset:6144
    s_waitcnt vmcnt(15) lgkmcnt(4)
    v_mfma_f32_32x32x16_bf16 v[128:143], v[176:179], v[8:11], v[128:143]
    ds_read_b64_tr_b16 v[160:161], v192 offset:8192
    ds_read_b64_tr_b16 v[162:163], v193 offset:8192
    buffer_load_dwordx4 v[72:75], v197, s[8:11], s31 offen sc1
    s_add_u32 s31, s31, 1024
    v_mfma_f32_32x32x16_bf16 v[144:159], v[180:183], v[8:11], v[144:159]
    ds_read_b64_tr_b16 v[164:165], v194 offset:8192
    ds_read_b64_tr_b16 v[166:167], v195 offset:8192
    s_waitcnt vmcnt(15) lgkmcnt(4)
    v_mfma_f32_32x32x16_bf16 v[128:143], v[184:187], v[12:15], v[128:143]
    ds_read_b64_tr_b16 v[168:169], v192 offset:10240
    ds_read_b64_tr_b16 v[170:171], v193 offset:10240
    buffer_load_dwordx4 v[76:79], v197, s[8:11], s31 offen sc1
    s_add_u32 s31, s31, 1024
    v_mfma_f32_32x32x16_bf16 v[144:159], v[188:191], v[12:15], v[144:159]
    ds_read_b64_tr_b16 v[172:173], v194 offset:10240
    ds_read_b64_tr_b16 v[174:175], v195 offset:10240
    s_waitcnt vmcnt(15) lgkmcnt(4)
    v_mfma_f32_32x32x16_bf16 v[128:143], v[160:163], v[16:19], v[128:143]
    ds_read_b64_tr_b16 v[176:177], v192 offset:12288
    ds_read_b64_tr_b16 v[178:179], v193 offset:12288
    buffer_load_dwordx4 v[80:83], v197, s[8:11], s31 offen sc1
    s_add_u32 s31, s31, 1024
    v_mfma_f32_32x32x16_bf16 v[144:159], v[164:167], v[16:19], v[144:159]
    ds_read_b64_tr_b16 v[180:181], v194 offset:12288
    ds_read_b64_tr_b16 v[182:183], v195 offset:12288
    s_waitcnt vmcnt(15) lgkmcnt(4)
    v_mfma_f32_32x32x16_bf16 v[128:143], v[168:171], v[20:23], v[128:143]
    ds_read_b64_tr_b16 v[184:185], v192 offset:14336
    ds_read_b64_tr_b16 v[186:187], v193 offset:14336
    buffer_load_dwordx4 v[84:87], v197, s[8:11], s31 offen sc1
    s_add_u32 s31, s31, 1024
    v_mfma_f32_32x32x16_bf16 v[144:159], v[172:175], v[20:23], v[144:159]
    ds_read_b64_tr_b16 v[188:189], v194 offset:14336
    ds_read_b64_tr_b16 v[190:191], v195 offset:14336
    s_waitcnt vmcnt(15) lgkmcnt(4)
    v_mfma_f32_32x32x16_bf16 v[128:143], v[176:179], v[24:27], v[128:143]
    buffer_load_dwordx4 v[88:91], v197, s[8:11], s31 offen sc1
    s_add_u32 s31, s31, 1024
    v_mfma_f32_32x32x16_bf16 v[144:159], v[180:183], v[24:27], v[144:159]
    s_waitcnt vmcnt(15) lgkmcnt(0)
    v_mfma_f32_32x32x16_bf16 v[128:143], v[184:187], v[28:31], v[128:143]
    buffer_load_dwordx4 v[92:95], v197, s[8:11], s31 offen sc1
    s_add_u32 s31, s31, 1024
    v_mfma_f32_32x32x16_bf16 v[144:159], v[188:191], v[28:31], v[144:159]
    ds_read_b64_tr_b16 v[160:161], v192 offset:16384
    ds_read_b64_tr_b16 v[162:163], v193 offset:16384
    ds_read_b64_tr_b16 v[164:165], v194 offset:16384
    ds_read_b64_tr_b16 v[166:167], v195 offset:16384
    ds_read_b64_tr_b16 v[168:169], v192 offset:18432
    ds_read_b64_tr_b16 v[170:171], v193 offset:18432
    ds_read_b64_tr_b16 v[172:173], v194 offset:18432
    ds_read_b64_tr_b16 v[174:175], v195 offset:18432
    s_waitcnt vmcnt(15) lgkmcnt(4)
    v_mfma_f32_32x32x16_bf16 v[128:143], v[160:163], v[32:35], v[128:143]
    ds_read_b64_tr_b16 v[176:177], v192 offset:20480
    ds_read_b64_tr_b16 v[178:179], v193 offset:20480
    buffer_load_dwordx4 v[96:99], v197, s[8:11], s31 offen sc1
    s_add_u32 s31, s31, 1024
    v_mfma_f32_32x32x16_bf16 v[144:159], v[164:167], v[32:35], v[144:159]
    ds_read_b64_tr_b16 v[180:181], v194 offset:20480
    ds_read_b64_tr_b16 v[182:183], v195 offset:20480
    s_waitcnt vmcnt(15) lgkmcnt(4)
    v_mfma_f32_32x32x16_bf16 v[128:143], v[168:171], v[36:39], v[128:143]
    ds_read_b64_tr_b16 v[184:185], v192 offset:22528
    ds_read_b64_tr_b16 v[186:187], v193 offset:22528
    buffer_load_dwordx4 v[100:103], v197, s[8:11], s31 offen sc1
    s_add_u32 s31, s31, 1024
    v_mfma_f32_32x32x16_bf16 v[144:159], v[172:175], v[36:39], v[144:159]
    ds_read_b64_tr_b16 v[188:189], v194 offset:22528
    ds_read_b64_tr_b16 v[190:191], v195 offset:22528
    s_waitcnt vmcnt(15) lgkmcnt(4)
    v_mfma_f32_32x32x16_bf16 v[128:143], v[176:179], v[40:43], v[128:143]
    ds_read_b64_tr_b16 v[160:161], v192 offset:24576
    ds_read_b64_tr_b16 v[162:163], v193 offset:24576
    buffer_load_dwordx4 v[104:107], v197, s[8:11], s31 offen sc1
    s_add_u32 s31, s31, 1024
    v_mfma_f32_32x32x16_bf16 v[144:159], v[180:183], v[40:43], v[144:159]
    ds_read_b64_tr_b16 v[164:165], v194 offset:24576
    ds_read_b64_tr_b16 v[166:167], v195 offset:24576
    s_waitcnt vmcnt(15) lgkmcnt(4)
    v_mfma_f32_32x32x16_bf16 v[128:143], v[184:187], v[44:47], v[128:143]
    ds_read_b64_tr_b16 v[168:169], v192 offset:26624
    ds_read_b64_tr_b16 v[170:171], v193 offset:26624
    buffer_load_dwordx4 v[108:111], v197, s[8:11], s31 offen sc1
    s_add_u32 s31, s31, 1024
    v_mfma_f32_32x32x16_bf16 v[144:159], v[188:191], v[44:47], v[144:159]
    ds_read_b64_tr_b16 v[172:173], v194 offset:26624
    ds_read_b64_tr_b16 v[174:175], v195 offset:26624
    s_waitcnt vmcnt(15) lgkmcnt(4)
    v_mfma_f32_32x32x16_bf16 v[128:143], v[160:163], v[48:51], v[128:143]
    ds_read_b64_tr_b16 v[176:177], v192 offset:28672
    ds_read_b64_tr_b16 v[178:179], v193 offset:28672
    buffer_load_dwordx4 v[112:115], v197, s[8:11], s31 offen sc1
    s_add_u32 s31, s31, 1024
    v_mfma_f32_32x32x16_bf16 v[144:159], v[164:167], v[48:51], v[144:159]
    ds_read_b64_tr_b16 v[180:181], v194 offset:28672
    ds_read_b64_tr_b16 v[182:183], v195 offset:28672
    s_waitcnt vmcnt(15) lgkmcnt(4)
    v_mfma_f32_32x32x16_bf16 v[128:143], v[168:171], v[52:55], v[128:143]
    ds_read_b64_tr_b16 v[184:185], v192 offset:30720
    ds_read_b64_tr_b16 v[186:187], v193 offset:30720
    buffer_load_dwordx4 v[116:119], v197, s[8:11], s31 offen sc1
    s_add_u32 s31, s31, 1024
    v_mfma_f32_32x32x16_bf16 v[144:159], v[172:175], v[52:55], v[144:159]
    ds_read_b64_tr_b16 v[188:189], v194 offset:30720
    ds_read_b64_tr_b16 v[190:191], v195 offset:30720
    s_waitcnt vmcnt(15) lgkmcnt(4)
    v_mfma_f32_32x32x16_bf16 v[128:143], v[176:179], v[56:59], v[128:143]
    buffer_load_dwordx4 v[120:123], v197, s[8:11], s31 offen sc1
    s_add_u32 s31, s31, 1024
    v_mfma_f32_32x32x16_bf16 v[144:159], v[180:183], v[56:59], v[144:159]
    s_waitcnt vmcnt(15) lgkmcnt(0)
    v_mfma_f32_32x32x16_bf16 v[128:143], v[184:187], v[60:63], v[128:143]
    buffer_load_dwordx4 v[124:127], v197, s[8:11], s31 offen sc1
    s_add_u32 s31, s31, 1024
    v_mfma_f32_32x32x16_bf16 v[144:159], v[188:191], v[60:63], v[144:159]
    ds_read_b64_tr_b16 v[160:161], v192 offset:32768
    ds_read_b64_tr_b16 v[162:163], v193 offset:32768
    ds_read_b64_tr_b16 v[164:165], v194 offset:32768
    ds_read_b64_tr_b16 v[166:167], v195 offset:32768
    ds_read_b64_tr_b16 v[168:169], v192 offset:34816
    ds_read_b64_tr_b16 v[170:171], v193 offset:34816
    ds_read_b64_tr_b16 v[172:173], v194 offset:34816
    ds_read_b64_tr_b16 v[174:175], v195 offset:34816
    s_waitcnt vmcnt(15) lgkmcnt(4)
    v_mfma_f32_32x32x16_bf16 v[128:143], v[160:163], v[64:67], v[128:143]
    ds_read_b64_tr_b16 v[176:177], v192 offset:36864
    ds_read_b64_tr_b16 v[178:179], v193 offset:36864
    v_mfma_f32_32x32x16_bf16 v[144:159], v[164:167], v[64:67], v[144:159]
    ds_read_b64_tr_b16 v[180:181], v194 offset:36864
    ds_read_b64_tr_b16 v[182:183], v195 offset:36864
    s_waitcnt vmcnt(14) lgkmcnt(4)
    v_mfma_f32_32x32x16_bf16 v[128:143], v[168:171], v[68:71], v[128:143]
    ds_read_b64_tr_b16 v[184:185], v192 offset:38912
    ds_read_b64_tr_b16 v[186:187], v193 offset:38912
    v_mfma_f32_32x32x16_bf16 v[144:159], v[172:175], v[68:71], v[144:159]
    ds_read_b64_tr_b16 v[188:189], v194 offset:38912
    ds_read_b64_tr_b16 v[190:191], v195 offset:38912
    s_waitcnt vmcnt(13) lgkmcnt(4)
    v_mfma_f32_32x32x16_bf16 v[128:143], v[176:179], v[72:75], v[128:143]
    ds_read_b64_tr_b16 v[160:161], v192 offset:40960
    ds_read_b64_tr_b16 v[162:163], v193 offset:40960
    v_mfma_f32_32x32x16_bf16 v[144:159], v[180:183], v[72:75], v[144:159]
    ds_read_b64_tr_b16 v[164:165], v194 offset:40960
    ds_read_b64_tr_b16 v[166:167], v195 offset:40960
    s_waitcnt vmcnt(12) lgkmcnt(4)
    v_mfma_f32_32x32x16_bf16 v[128:143], v[184:187], v[76:79], v[128:143]
    ds_read_b64_tr_b16 v[168:169], v192 offset:43008
    ds_read_b64_tr_b16 v[170:171], v193 offset:43008
    v_mfma_f32_32x32x16_bf16 v[144:159], v[188:191], v[76:79], v[144:159]
    ds_read_b64_tr_b16 v[172:173], v194 offset:43008
    ds_read_b64_tr_b16 v[174:175], v195 offset:43008
    s_waitcnt vmcnt(11) lgkmcnt(4)
    v_mfma_f32_32x32x16_bf16 v[128:143], v[160:163], v[80:83], v[128:143]
    ds_read_b64_tr_b16 v[176:177], v192 offset:45056
    ds_read_b64_tr_b16 v[178:179], v193 offset:45056
    v_mfma_f32_32x32x16_bf16 v[144:159], v[164:167], v[80:83], v[144:159]
    ds_read_b64_tr_b16 v[180:181], v194 offset:45056
    ds_read_b64_tr_b16 v[182:183], v195 offset:45056
    s_waitcnt vmcnt(10) lgkmcnt(4)
    v_mfma_f32_32x32x16_bf16 v[128:143], v[168:171], v[84:87], v[128:143]
    ds_read_b64_tr_b16 v[184:185], v192 offset:47104
    ds_read_b64_tr_b16 v[186:187], v193 offset:47104
    v_mfma_f32_32x32x16_bf16 v[144:159], v[172:175], v[84:87], v[144:159]
    ds_read_b64_tr_b16 v[188:189], v194 offset:47104
    ds_read_b64_tr_b16 v[190:191], v195 offset:47104
    s_waitcnt vmcnt(9) lgkmcnt(4)
    v_mfma_f32_32x32x16_bf16 v[128:143], v[176:179], v[88:91], v[128:143]
    v_mfma_f32_32x32x16_bf16 v[144:159], v[180:183], v[88:91], v[144:159]
    s_waitcnt vmcnt(8) lgkmcnt(0)
    v_mfma_f32_32x32x16_bf16 v[128:143], v[184:187], v[92:95], v[128:143]
    v_mfma_f32_32x32x16_bf16 v[144:159], v[188:191], v[92:95], v[144:159]
    ds_read_b64_tr_b16 v[160:161], v192 offset:49152
    ds_read_b64_tr_b16 v[162:163], v193 offset:49152
    ds_read_b64_tr_b16 v[164:165], v194 offset:49152
    ds_read_b64_tr_b16 v[166:167], v195 offset:49152
    ds_read_b64_tr_b16 v[168:169], v192 offset:51200
    ds_read_b64_tr_b16 v[170:171], v193 offset:51200
    ds_read_b64_tr_b16 v[172:173], v194 offset:51200
    ds_read_b64_tr_b16 v[174:175], v195 offset:51200
    s_waitcnt vmcnt(7) lgkmcnt(4)
    v_mfma_f32_32x32x16_bf16 v[128:143], v[160:163], v[96:99], v[128:143]
    ds_read_b64_tr_b16 v[176:177], v192 offset:53248
    ds_read_b64_tr_b16 v[178:179], v193 offset:53248
    v_mfma_f32_32x32x16_bf16 v[144:159], v[164:167], v[96:99], v[144:159]
    ds_read_b64_tr_b16 v[180:181], v194 offset:53248
    ds_read_b64_tr_b16 v[182:183], v195 offset:53248
    s_waitcnt vmcnt(6) lgkmcnt(4)
    v_mfma_f32_32x32x16_bf16 v[128:143], v[168:171], v[100:103], v[128:143]
    ds_read_b64_tr_b16 v[184:185], v192 offset:55296
    ds_read_b64_tr_b16 v[186:187], v193 offset:55296
    v_mfma_f32_32x32x16_bf16 v[144:159], v[172:175], v[100:103], v[144:159]
    ds_read_b64_tr_b16 v[188:189], v194 offset:55296
    ds_read_b64_tr_b16 v[190:191], v195 offset:55296
    s_waitcnt vmcnt(5) lgkmcnt(4)
    v_mfma_f32_32x32x16_bf16 v[128:143], v[176:179], v[104:107], v[128:143]
    ds_read_b64_tr_b16 v[160:161], v192 offset:57344
    ds_read_b64_tr_b16 v[162:163], v193 offset:57344
    v_mfma_f32_32x32x16_bf16 v[144:159], v[180:183], v[104:107], v[144:159]
    ds_read_b64_tr_b16 v[164:165], v194 offset:57344
    ds_read_b64_tr_b16 v[166:167], v195 offset:57344
    s_waitcnt vmcnt(4) lgkmcnt(4)
    v_mfma_f32_32x32x16_bf16 v[128:143], v[184:187], v[108:111], v[128:143]
    ds_read_b64_tr_b16 v[168:169], v192 offset:59392
    ds_read_b64_tr_b16 v[170:171], v193 offset:59392
    v_mfma_f32_32x32x16_bf16 v[144:159], v[188:191], v[108:111], v[144:159]
    ds_read_b64_tr_b16 v[172:173], v194 offset:59392
    ds_read_b64_tr_b16 v[174:175], v195 offset:59392
    s_waitcnt vmcnt(3) lgkmcnt(4)
    v_mfma_f32_32x32x16_bf16 v[128:143], v[160:163], v[112:115], v[128:143]
    ds_read_b64_tr_b16 v[176:177], v192 offset:61440
    ds_read_b64_tr_b16 v[178:179], v193 offset:61440
    v_mfma_f32_32x32x16_bf16 v[144:159], v[164:167], v[112:115], v[144:159]
    ds_read_b64_tr_b16 v[180:181], v194 offset:61440
    ds_read_b64_tr_b16 v[182:183], v195 offset:61440
    s_waitcnt vmcnt(2) lgkmcnt(4)
    v_mfma_f32_32x32x16_bf16 v[128:143], v[168:171], v[116:119], v[128:143]
    ds_read_b64_tr_b16 v[184:185], v192 offset:63488
    ds_read_b64_tr_b16 v[186:187], v193 offset:63488
    v_mfma_f32_32x32x16_bf16 v[144:159], v[172:175], v[116:119], v[144:159]
    ds_read_b64_tr_b16 v[188:189], v194 offset:63488
    ds_read_b64_tr_b16 v[190:191], v195 offset:63488
    s_waitcnt vmcnt(1) lgkmcnt(4)
    v_mfma_f32_32x32x16_bf16 v[128:143], v[176:179], v[120:123], v[128:143]
    v_mfma_f32_32x32x16_bf16 v[144:159], v[180:183], v[120:123], v[144:159]
    s_waitcnt vmcnt(0) lgkmcnt(0)
    v_mfma_f32_32x32x16_bf16 v[128:143], v[184:187], v[124:127], v[128:143]
    v_mfma_f32_32x32x16_bf16 v[144:159], v[188:191], v[124:127], v[144:159]
    s_branch k3_epi
.section .rodata,"a"
.p2align 6
.amdhsa_kernel k1_qkv_kernel
  .amdhsa_next_free_vgpr 240
  .amdhsa_next_free_sgpr 102
  .amdhsa_accum_offset 240
  .amdhsa_group_segment_fixed_size 0
  .amdhsa_kernarg_size 72
  .amdhsa_user_sgpr_count 2
  .amdhsa_user_sgpr_kernarg_segment_ptr 1
  .amdhsa_system_sgpr_workgroup_id_x 1
.end_amdhsa_kernel
.p2align 6
.amdhsa_kernel k2_attn_kernel
  .amdhsa_next_free_vgpr 208
  .amdhsa_next_free_sgpr 102
  .amdhsa_accum_offset 208
  .amdhsa_group_segment_fixed_size 0
  .amdhsa_kernarg_size 72
  .amdhsa_user_sgpr_count 2
  .amdhsa_user_sgpr_kernarg_segment_ptr 1
  .amdhsa_system_sgpr_workgroup_id_x 1
.end_amdhsa_kernel
```
